```python
import torch

def _softmax(x, axis=-1):
    return torch.softmax(x, dim=axis)
def _gelu(x):
    return torch.nn.functional.gelu(x, approximate="tanh")
def _silu(x):
    return torch.nn.functional.silu(x)
def _sigmoid(x):
    return torch.sigmoid(x)
def _layernorm(x, axis=-1, eps=1e-5):
    m = x.mean(dim=axis, keepdim=True)
    v = x.var(dim=axis, keepdim=True, unbiased=False)
    return (x - m) / torch.sqrt(v + eps)
def _scatter_add(tgt, idx, src, axis=0):
    return tgt.clone().index_add_(axis, idx, src)
def _segment_sum(src, seg, n):
    out = torch.zeros((n,) + src.shape[1:], dtype=src.dtype)
    return out.index_add_(0, seg, src)
def _pad(x, pw):
    flat = tuple(v for pair in reversed(pw) for v in pair)
    return torch.nn.functional.pad(x, flat)

kernel_name = 'gated_mix__mha_block_cached__dense_activation_silu__decode'

def setup_inputs():

    _w = (lambda a: (lambda t: t.to(torch.bfloat16) if t.is_floating_point() else t)(torch.as_tensor(a)))
    def _A_setup():
        B, Sq, D = 2, 1, 512
        H, Sk, Dh = 32, 8192, 128
        return {
            "x": _w((lambda *s: torch.randn(*s, dtype=torch.bfloat16) * 0.05)(B, Sq, D)),
            "k_cache": _w((lambda *s: torch.randn(*s, dtype=torch.bfloat16) * 3.2)(B, H, Sk, Dh)),
            "v_cache": _w((lambda *s: torch.randn(*s, dtype=torch.bfloat16) * 0.1)(B, H, Sk, Dh)),
            "wq": _w((lambda *s: torch.randn(*s, dtype=torch.bfloat16) * 3.2)(D, H * Dh) * (D ** -0.5)),
            "wo": _w((lambda *s: torch.randn(*s, dtype=torch.bfloat16) * 0.1)(H * Dh, D) * ((H * Dh) ** -0.5)),
        }
    _A_in = _A_setup()

    def _B_setup():
        B, S, D, F = 2, 1, 512, 1792
        return {
            "x": _w((lambda *s: torch.randn(*s, dtype=torch.bfloat16) * 0.05)(B, S, D)),
            "w1": _w((lambda *s: torch.randn(*s, dtype=torch.bfloat16) * 0.05)(D, F) * (D ** -0.5)),
            "w2": _w((lambda *s: torch.randn(*s, dtype=torch.bfloat16) * 0.05)(F, D) * (F ** -0.5)),
        }
    _B_in = _B_setup()

    return {
        "A_x": _A_in["x"],
        "A_k_cache": _A_in["k_cache"],
        "A_v_cache": _A_in["v_cache"],
        "A_wq": _A_in["wq"],
        "A_wo": _A_in["wo"],
        "B_x": _B_in["x"],
        "B_w1": _B_in["w1"],
        "B_w2": _B_in["w2"],
        "gate_w": _w((lambda *s: torch.randn(*s, dtype=torch.bfloat16) * 0.05)(512) * 16.0),
    }

def reference(A_x, A_k_cache, A_v_cache, A_wq, A_wo, B_x, B_w1, B_w2, gate_w):
    def _A_ref(x, k_cache, v_cache, wq, wo):
        B, Sq, D = x.shape
        H, Dh = 32, 128
        q = (lambda x, *d: x.permute(*d))((x @ wq).reshape(B, Sq, H, Dh), 0, 2, 1, 3)
        scores = torch.einsum("bhqd,bhkd->bhqk", q, k_cache) * (Dh ** -0.5)
        p = _softmax(scores, axis=-1)
        o = torch.einsum("bhqk,bhkd->bhqd", p, v_cache)
        return (lambda x, *d: x.permute(*d))(o, 0, 2, 1, 3).reshape(B, Sq, H * Dh) @ wo

    def _B_ref(x, w1, w2):
        h = torch.einsum("bsd,df->bsf", x, w1)
        h = _silu(h)
        out = torch.einsum("bsf,fd->bsd", h, w2)
        return out

    x = A_x
    g = _sigmoid((x * gate_w).sum(-1, keepdims=True))
    a = _A_ref(x, A_k_cache, A_v_cache, A_wq, A_wo)
    b = _B_ref(x, B_w1, B_w2)
    return g * a + (1 - g) * b
```

```asm
; @launch kernel=attn_kernel grid=(256,1,1) block=(512,1,1) lds=152064
; @launch kernel=fin_kernel grid=(64,1,1) block=(256,1,1) lds=1024
.amdgcn_target "amdgcn-amd-amdhsa--gfx950"
.text
.globl attn_kernel
.p2align 8
.type attn_kernel,@function
attn_kernel:
  s_cmp_ge_u32 s2, 256
  s_cbranch_scc1 L1_done
  s_load_dwordx16 s[4:19], s[0:1], 0
  s_load_dwordx8 s[20:27], s[0:1], 64
  v_lshrrev_b32 v1, 6, v0
  v_and_b32 v0, 63, v0
  s_nop 0
  v_readfirstlane_b32 s3, v1
  s_mov_b32 s65, 0x05040100
  s_mov_b32 s66, 0x07060302
  s_mov_b32 s67, 0x3fb8aa3b
  s_mov_b32 s68, 0x3db504f3
  s_and_b32 s60, s2, 7
  s_lshr_b32 s61, s2, 3
  s_and_b32 s62, s61, 3
  s_lshl_b32 s62, s62, 3
  s_add_u32 s62, s62, s60
  s_lshr_b32 s61, s61, 2
  s_lshr_b32 s63, s61, 2
  s_and_b32 s64, s61, 3
  v_mov_b32 v249, 0
  v_mov_b32 v250, 1
  v_lshrrev_b32 v1, 4, v0
  v_and_b32 v2, 15, v0
  v_lshlrev_b32 v3, 8, v2
  v_lshl_add_u32 v3, v1, 4, v3
  v_lshlrev_b32 v4, 4, v2
  v_lshl_add_u32 v4, v1, 10, v4
  v_and_b32 v8, 1, v1
  v_lshrrev_b32 v9, 1, v1
  v_lshlrev_b32 v7, 5, v2
  v_lshl_add_u32 v7, v8, 3, v7
  v_lshl_add_u32 v7, v9, 4, v7
  s_lshl_b32 s61, s3, 9
  v_add_u32 v7, s61, v7
  s_lshl_b32 s85, s63, 5
  s_add_u32 s85, s85, s62
  s_lshl_b32 s60, s85, 21
  s_lshl_b32 s71, s3, 14
  s_add_u32 s71, s71, 16384
  s_mov_b32 s89, 20
  s_mov_b32 s86, 0
  s_mov_b32 s84, 0
  s_mov_b32 s82, 0
  s_waitcnt lgkmcnt(0)
  s_mov_b32 s28, s4
  s_mov_b32 s29, s5
  s_mov_b32 s30, 0x800
  s_mov_b32 s31, 0x00020000
  s_mov_b32 s32, s10
  s_mov_b32 s33, s11
  s_mov_b32 s34, 0x400000
  s_mov_b32 s35, 0x00020000
  s_mov_b32 s36, s6
  s_mov_b32 s37, s7
  s_mov_b32 s38, 0x8000000
  s_mov_b32 s39, 0x00020000
  s_mov_b32 s40, s8
  s_mov_b32 s41, s9
  s_mov_b32 s42, 0x8000000
  s_mov_b32 s43, 0x00020000
  s_mov_b32 s44, s12
  s_mov_b32 s45, s13
  s_mov_b32 s46, 0x400000
  s_mov_b32 s47, 0x00020000
  s_mov_b32 s48, s26
  s_mov_b32 s49, s27
  s_mov_b32 s50, 0x20000000
  s_mov_b32 s51, 0x00020000
  s_mov_b32 s52, s16
  s_mov_b32 s53, s17
  s_mov_b32 s54, 0x1c0000
  s_mov_b32 s55, 0x00020000
  s_mov_b32 s56, s18
  s_mov_b32 s57, s19
  s_mov_b32 s58, 0x1c0000
  s_mov_b32 s59, 0x00020000
  s_cmp_lt_u32 s85, 56
  s_cbranch_scc1 L1_ffngrp
  s_mov_b32 s8, 32
  s_mov_b32 s9, 0
  s_mov_b32 s10, 128
  s_mov_b32 s88, 0
  s_branch L1_mapdone
L1_ffngrp:
  s_mov_b32 s8, 30
  s_mov_b32 s9, 120
  s_mov_b32 s10, 132
  s_cmp_eq_u32 s64, 2
  s_cselect_b32 s9, 123, s9
  s_cselect_b32 s10, 132, s10
  s_cmp_eq_u32 s64, 3
  s_cselect_b32 s9, 126, s9
  s_cselect_b32 s10, 128, s10
  s_cmp_eq_u32 s64, 0
  s_cselect_b32 s10, 120, s10
  s_cselect_b32 s88, 1, 0
L1_mapdone:
  s_cmp_lt_u32 s3, 4
  s_cbranch_scc1 L1_pathA
  s_setprio 2
  s_cmp_lg_u32 s3, 7
  s_cbranch_scc1 L1_nocpf
  s_getpc_b64 s[12:13]
L1_pcref:
  s_sub_u32 s12, s12, L1_pcref-attn_kernel
  s_subb_u32 s13, s13, 0
  s_lshr_b32 s61, s2, 3
  s_lshl_b32 s61, s61, 11
  v_lshlrev_b32 v8, 7, v0
  v_add_u32 v8, s61, v8
  s_mov_b32 s61, L2_codeend-attn_kernel
  v_cmp_gt_u32 vcc, s61, v8
  s_mov_b64 s[14:15], 0xffff
  s_and_b64 vcc, vcc, s[14:15]
  s_and_saveexec_b64 s[14:15], vcc
  s_cbranch_execz L1_cpf_skip
  global_load_dword v253, v8, s[12:13]
L1_cpf_skip:
  s_mov_b64 exec, s[14:15]
L1_nocpf:
  s_sub_u32 s61, s3, 4
  s_mul_i32 s61, s61, 5
  s_mov_b32 s15, s61
  s_lshr_b32 s12, s15, 2
  s_lshl_b32 s13, s12, 2
  s_add_u32 s13, s13, s64
  s_sub_u32 s14, s12, s8
  s_add_u32 s14, s14, s9
  s_cmp_lt_u32 s12, s8
  s_cselect_b32 s13, s13, s14
  s_lshl_b32 s13, s13, 14
  s_and_b32 s12, s15, 3
  s_lshl_b32 s12, s12, 12
  s_add_u32 s13, s13, s12
  s_add_u32 s13, s13, s60
  s_cmp_lt_u32 s15, s10
  s_cselect_b32 s72, s13, 0x40000000
  buffer_load_dwordx4 v[56:59], v4, s[36:39], s72 offen offset:0 nt
  buffer_load_dwordx4 v[60:63], v4, s[36:39], s72 offen offset:256 nt
  buffer_load_dwordx4 v[64:67], v4, s[36:39], s72 offen offset:512 nt
  buffer_load_dwordx4 v[68:71], v4, s[36:39], s72 offen offset:768 nt
  buffer_load_dwordx4 v[72:75], v4, s[40:43], s72 offen offset:0 nt
  buffer_load_dwordx4 v[76:79], v4, s[40:43], s72 offen offset:256 nt
  buffer_load_dwordx4 v[80:83], v4, s[40:43], s72 offen offset:512 nt
  buffer_load_dwordx4 v[84:87], v4, s[40:43], s72 offen offset:768 nt
  s_add_u32 s15, s15, 1
  s_lshr_b32 s12, s15, 2
  s_lshl_b32 s13, s12, 2
  s_add_u32 s13, s13, s64
  s_sub_u32 s14, s12, s8
  s_add_u32 s14, s14, s9
  s_cmp_lt_u32 s12, s8
  s_cselect_b32 s13, s13, s14
  s_lshl_b32 s13, s13, 14
  s_and_b32 s12, s15, 3
  s_lshl_b32 s12, s12, 12
  s_add_u32 s13, s13, s12
  s_add_u32 s13, s13, s60
  s_cmp_lt_u32 s15, s10
  s_cselect_b32 s73, s13, 0x40000000
  s_add_u32 s15, s15, 1
  s_lshr_b32 s12, s15, 2
  s_lshl_b32 s13, s12, 2
  s_add_u32 s13, s13, s64
  s_sub_u32 s14, s12, s8
  s_add_u32 s14, s14, s9
  s_cmp_lt_u32 s12, s8
  s_cselect_b32 s13, s13, s14
  s_lshl_b32 s13, s13, 14
  s_and_b32 s12, s15, 3
  s_lshl_b32 s12, s12, 12
  s_add_u32 s13, s13, s12
  s_add_u32 s13, s13, s60
  s_cmp_lt_u32 s15, s10
  s_cselect_b32 s74, s13, 0x40000000
  s_add_u32 s15, s15, 1
  s_lshr_b32 s12, s15, 2
  s_lshl_b32 s13, s12, 2
  s_add_u32 s13, s13, s64
  s_sub_u32 s14, s12, s8
  s_add_u32 s14, s14, s9
  s_cmp_lt_u32 s12, s8
  s_cselect_b32 s13, s13, s14
  s_lshl_b32 s13, s13, 14
  s_and_b32 s12, s15, 3
  s_lshl_b32 s12, s12, 12
  s_add_u32 s13, s13, s12
  s_add_u32 s13, s13, s60
  s_cmp_lt_u32 s15, s10
  s_cselect_b32 s75, s13, 0x40000000
  s_add_u32 s15, s15, 1
  s_lshr_b32 s12, s15, 2
  s_lshl_b32 s13, s12, 2
  s_add_u32 s13, s13, s64
  s_sub_u32 s14, s12, s8
  s_add_u32 s14, s14, s9
  s_cmp_lt_u32 s12, s8
  s_cselect_b32 s13, s13, s14
  s_lshl_b32 s13, s13, 14
  s_and_b32 s12, s15, 3
  s_lshl_b32 s12, s12, 12
  s_add_u32 s13, s13, s12
  s_add_u32 s13, s13, s60
  s_cmp_lt_u32 s15, s10
  s_cselect_b32 s76, s13, 0x40000000
  s_add_u32 s61, s89, 16
  v_mov_b32 v14, s61
  v_mov_b32 v15, 0
  v_mov_b32 v16, 0
  v_mov_b32 v17, 0
  v_mov_b32 v18, 0
  v_mov_b32 v19, 0
  ds_write_b64 v249, v[14:15] offset:8328
  ds_write_b128 v249, v[16:19] offset:8336
  s_waitcnt lgkmcnt(0)
  s_barrier
  buffer_load_dwordx4 v[88:91], v4, s[36:39], s73 offen offset:0 nt
  buffer_load_dwordx4 v[92:95], v4, s[36:39], s73 offen offset:256 nt
  buffer_load_dwordx4 v[96:99], v4, s[36:39], s73 offen offset:512 nt
  buffer_load_dwordx4 v[100:103], v4, s[36:39], s73 offen offset:768 nt
  buffer_load_dwordx4 v[104:107], v4, s[40:43], s73 offen offset:0 nt
  buffer_load_dwordx4 v[108:111], v4, s[40:43], s73 offen offset:256 nt
  buffer_load_dwordx4 v[112:115], v4, s[40:43], s73 offen offset:512 nt
  buffer_load_dwordx4 v[116:119], v4, s[40:43], s73 offen offset:768 nt
  s_waitcnt vmcnt(8)
  buffer_load_dwordx4 v[120:123], v4, s[36:39], s74 offen offset:0 nt
  buffer_load_dwordx4 v[124:127], v4, s[36:39], s74 offen offset:256 nt
  buffer_load_dwordx4 v[128:131], v4, s[36:39], s74 offen offset:512 nt
  buffer_load_dwordx4 v[132:135], v4, s[36:39], s74 offen offset:768 nt
  buffer_load_dwordx4 v[136:139], v4, s[40:43], s74 offen offset:0 nt
  buffer_load_dwordx4 v[140:143], v4, s[40:43], s74 offen offset:256 nt
  buffer_load_dwordx4 v[144:147], v4, s[40:43], s74 offen offset:512 nt
  buffer_load_dwordx4 v[148:151], v4, s[40:43], s74 offen offset:768 nt
  s_waitcnt vmcnt(8)
  buffer_load_dwordx4 v[152:155], v4, s[36:39], s75 offen offset:0 nt
  buffer_load_dwordx4 v[156:159], v4, s[36:39], s75 offen offset:256 nt
  buffer_load_dwordx4 v[160:163], v4, s[36:39], s75 offen offset:512 nt
  buffer_load_dwordx4 v[164:167], v4, s[36:39], s75 offen offset:768 nt
  buffer_load_dwordx4 v[168:171], v4, s[40:43], s75 offen offset:0 nt
  buffer_load_dwordx4 v[172:175], v4, s[40:43], s75 offen offset:256 nt
  buffer_load_dwordx4 v[176:179], v4, s[40:43], s75 offen offset:512 nt
  buffer_load_dwordx4 v[180:183], v4, s[40:43], s75 offen offset:768 nt
  s_waitcnt vmcnt(8)
  buffer_load_dwordx4 v[184:187], v4, s[36:39], s76 offen offset:0 nt
  buffer_load_dwordx4 v[188:191], v4, s[36:39], s76 offen offset:256 nt
  buffer_load_dwordx4 v[192:195], v4, s[36:39], s76 offen offset:512 nt
  buffer_load_dwordx4 v[196:199], v4, s[36:39], s76 offen offset:768 nt
  buffer_load_dwordx4 v[200:203], v4, s[40:43], s76 offen offset:0 nt
  buffer_load_dwordx4 v[204:207], v4, s[40:43], s76 offen offset:256 nt
  buffer_load_dwordx4 v[208:211], v4, s[40:43], s76 offen offset:512 nt
  buffer_load_dwordx4 v[212:215], v4, s[40:43], s76 offen offset:768 nt
L1_poll0:
  ds_read_b32 v8, v249 offset:8332
  s_waitcnt lgkmcnt(0)
  v_readfirstlane_b32 s61, v8
  s_cmp_ge_u32 s61, 4
  s_cbranch_scc1 L1_polled0
  s_sleep 1
  s_branch L1_poll0
L1_polled0:
  v_lshlrev_b32 v8, 3, v0
  ds_read_b64 v[24:25], v8 offset:0
  ds_read_b64 v[26:27], v8 offset:512
  ds_read_b64 v[28:29], v8 offset:1024
  ds_read_b64 v[30:31], v8 offset:1536
  s_lshl_b32 s61, s3, 8
  v_lshlrev_b32 v9, 2, v0
  v_add_u32 v9, s61, v9
  v_lshlrev_b32 v10, 4, v2
  v_add_u32 v10, s61, v10
  v_lshlrev_b32 v12, 4, v1
  v_add_u32 v12, s61, v12
  s_waitcnt lgkmcnt(0)
  v_add_f32 v24, v24, v26
  v_add_f32 v25, v25, v27
  v_add_f32 v28, v28, v30
  v_add_f32 v29, v29, v31
  v_add_f32 v24, v24, v28
  v_add_f32 v25, v25, v29
  v_cvt_pk_bf16_f32 v11, v24, v25
  ds_write_b32 v9, v11 offset:2048
  s_waitcnt lgkmcnt(0)
  ds_read_b128 v[52:55], v10 offset:2048
  ds_read_b128 v[24:27], v12 offset:2048
  ds_read_b128 v[28:31], v12 offset:2112
  ds_read_b128 v[32:35], v12 offset:2176
  ds_read_b128 v[36:39], v12 offset:2240
  v_mov_b32 v5, 0xff61b1e6
  v_mov_b32 v6, 0
  v_mov_b32 v40, 0
  v_mov_b32 v41, 0
  v_mov_b32 v42, 0
  v_mov_b32 v43, 0
  v_mov_b32 v44, 0
  v_mov_b32 v45, 0
  v_mov_b32 v46, 0
  v_mov_b32 v47, 0
  s_waitcnt lgkmcnt(0)
  v_dot2_f32_bf16 v48, v56, v52, 0
  v_dot2_f32_bf16 v49, v60, v52, 0
  v_dot2_f32_bf16 v50, v64, v52, 0
  v_dot2_f32_bf16 v51, v68, v52, 0
  v_dot2_f32_bf16 v48, v57, v53, v48
  v_dot2_f32_bf16 v49, v61, v53, v49
  v_dot2_f32_bf16 v50, v65, v53, v50
  v_dot2_f32_bf16 v51, v69, v53, v51
  v_dot2_f32_bf16 v48, v58, v54, v48
  v_dot2_f32_bf16 v49, v62, v54, v49
  v_dot2_f32_bf16 v50, v66, v54, v50
  v_dot2_f32_bf16 v51, v70, v54, v51
  v_dot2_f32_bf16 v48, v59, v55, v48
  v_dot2_f32_bf16 v49, v63, v55, v49
  v_dot2_f32_bf16 v50, v67, v55, v50
  v_dot2_f32_bf16 v51, v71, v55, v51
  s_nop 0
  v_add_f32_dpp v48, v48, v48 row_ror:8 row_mask:0xf bank_mask:0xf
  v_add_f32_dpp v49, v49, v49 row_ror:8 row_mask:0xf bank_mask:0xf
  v_add_f32_dpp v50, v50, v50 row_ror:8 row_mask:0xf bank_mask:0xf
  v_add_f32_dpp v51, v51, v51 row_ror:8 row_mask:0xf bank_mask:0xf
  v_add_f32_dpp v48, v48, v48 row_ror:4 row_mask:0xf bank_mask:0xf
  v_add_f32_dpp v49, v49, v49 row_ror:4 row_mask:0xf bank_mask:0xf
  v_add_f32_dpp v50, v50, v50 row_ror:4 row_mask:0xf bank_mask:0xf
  v_add_f32_dpp v51, v51, v51 row_ror:4 row_mask:0xf bank_mask:0xf
  v_add_f32_dpp v48, v48, v48 row_ror:2 row_mask:0xf bank_mask:0xf
  v_add_f32_dpp v49, v49, v49 row_ror:2 row_mask:0xf bank_mask:0xf
  v_add_f32_dpp v50, v50, v50 row_ror:2 row_mask:0xf bank_mask:0xf
  v_add_f32_dpp v51, v51, v51 row_ror:2 row_mask:0xf bank_mask:0xf
  v_add_f32_dpp v48, v48, v48 row_ror:1 row_mask:0xf bank_mask:0xf
  v_add_f32_dpp v49, v49, v49 row_ror:1 row_mask:0xf bank_mask:0xf
  v_add_f32_dpp v50, v50, v50 row_ror:1 row_mask:0xf bank_mask:0xf
  v_add_f32_dpp v51, v51, v51 row_ror:1 row_mask:0xf bank_mask:0xf
  v_cvt_pk_bf16_f32 v16, v48, v49
  v_lshlrev_b32 v48, 16, v16
  v_and_b32 v49, 0xffff0000, v16
  v_mul_f32 v48, s68, v48
  v_mul_f32 v49, s68, v49
  v_cvt_pk_bf16_f32 v16, v48, v49
  v_lshlrev_b32 v48, 16, v16
  v_and_b32 v49, 0xffff0000, v16
  v_cvt_pk_bf16_f32 v16, v50, v51
  v_lshlrev_b32 v50, 16, v16
  v_and_b32 v51, 0xffff0000, v16
  v_mul_f32 v50, s68, v50
  v_mul_f32 v51, s68, v51
  v_cvt_pk_bf16_f32 v16, v50, v51
  v_lshlrev_b32 v50, 16, v16
  v_and_b32 v51, 0xffff0000, v16
  v_max3_f32 v8, v48, v49, v5
  v_max3_f32 v8, v50, v51, v8
  v_sub_f32 v9, v5, v8
  v_mul_f32 v10, s67, v8
  v_mul_f32 v9, s67, v9
  v_fma_f32 v12, v48, s67, -v10
  v_fma_f32 v13, v49, s67, -v10
  v_fma_f32 v14, v50, s67, -v10
  v_fma_f32 v15, v51, s67, -v10
  v_exp_f32 v9, v9
  v_exp_f32 v12, v12
  v_exp_f32 v13, v13
  v_exp_f32 v14, v14
  v_exp_f32 v15, v15
  v_mov_b32 v5, v8
  v_mul_f32 v40, v9, v40
  v_mul_f32 v41, v9, v41
  v_mul_f32 v42, v9, v42
  v_mul_f32 v43, v9, v43
  v_mul_f32 v44, v9, v44
  v_mul_f32 v45, v9, v45
  v_mul_f32 v46, v9, v46
  v_mul_f32 v47, v9, v47
  v_cvt_pk_bf16_f32 v18, v12, v13
  v_cvt_pk_bf16_f32 v19, v14, v15
  v_add_f32 v16, v12, v13
  v_add_f32 v17, v14, v15
  v_add_f32 v16, v16, v17
  v_fma_f32 v6, v6, v9, v16
  v_perm_b32 v20, v76, v72, s65
  v_perm_b32 v21, v76, v72, s66
  v_dot2_f32_bf16 v40, v20, v18, v40
  v_dot2_f32_bf16 v41, v21, v18, v41
  v_perm_b32 v22, v77, v73, s65
  v_perm_b32 v11, v77, v73, s66
  v_dot2_f32_bf16 v42, v22, v18, v42
  v_dot2_f32_bf16 v43, v11, v18, v43
  v_perm_b32 v20, v78, v74, s65
  v_perm_b32 v21, v78, v74, s66
  v_dot2_f32_bf16 v44, v20, v18, v44
  v_dot2_f32_bf16 v45, v21, v18, v45
  v_perm_b32 v22, v79, v75, s65
  v_perm_b32 v11, v79, v75, s66
  v_dot2_f32_bf16 v46, v22, v18, v46
  v_dot2_f32_bf16 v47, v11, v18, v47
  v_perm_b32 v20, v84, v80, s65
  v_perm_b32 v21, v84, v80, s66
  v_dot2_f32_bf16 v40, v20, v19, v40
  v_dot2_f32_bf16 v41, v21, v19, v41
  v_perm_b32 v22, v85, v81, s65
  v_perm_b32 v11, v85, v81, s66
  v_dot2_f32_bf16 v42, v22, v19, v42
  v_dot2_f32_bf16 v43, v11, v19, v43
  v_perm_b32 v20, v86, v82, s65
  v_perm_b32 v21, v86, v82, s66
  v_dot2_f32_bf16 v44, v20, v19, v44
  v_dot2_f32_bf16 v45, v21, v19, v45
  v_perm_b32 v22, v87, v83, s65
  v_perm_b32 v11, v87, v83, s66
  v_dot2_f32_bf16 v46, v22, v19, v46
  v_dot2_f32_bf16 v47, v11, v19, v47
  v_dot2_f32_bf16 v48, v88, v52, 0
  v_dot2_f32_bf16 v49, v92, v52, 0
  v_dot2_f32_bf16 v50, v96, v52, 0
  v_dot2_f32_bf16 v51, v100, v52, 0
  v_dot2_f32_bf16 v48, v89, v53, v48
  v_dot2_f32_bf16 v49, v93, v53, v49
  v_dot2_f32_bf16 v50, v97, v53, v50
  v_dot2_f32_bf16 v51, v101, v53, v51
  v_dot2_f32_bf16 v48, v90, v54, v48
  v_dot2_f32_bf16 v49, v94, v54, v49
  v_dot2_f32_bf16 v50, v98, v54, v50
  v_dot2_f32_bf16 v51, v102, v54, v51
  v_dot2_f32_bf16 v48, v91, v55, v48
  v_dot2_f32_bf16 v49, v95, v55, v49
  v_dot2_f32_bf16 v50, v99, v55, v50
  v_dot2_f32_bf16 v51, v103, v55, v51
  s_nop 0
  v_add_f32_dpp v48, v48, v48 row_ror:8 row_mask:0xf bank_mask:0xf
  v_add_f32_dpp v49, v49, v49 row_ror:8 row_mask:0xf bank_mask:0xf
  v_add_f32_dpp v50, v50, v50 row_ror:8 row_mask:0xf bank_mask:0xf
  v_add_f32_dpp v51, v51, v51 row_ror:8 row_mask:0xf bank_mask:0xf
  v_add_f32_dpp v48, v48, v48 row_ror:4 row_mask:0xf bank_mask:0xf
  v_add_f32_dpp v49, v49, v49 row_ror:4 row_mask:0xf bank_mask:0xf
  v_add_f32_dpp v50, v50, v50 row_ror:4 row_mask:0xf bank_mask:0xf
  v_add_f32_dpp v51, v51, v51 row_ror:4 row_mask:0xf bank_mask:0xf
  v_add_f32_dpp v48, v48, v48 row_ror:2 row_mask:0xf bank_mask:0xf
  v_add_f32_dpp v49, v49, v49 row_ror:2 row_mask:0xf bank_mask:0xf
  v_add_f32_dpp v50, v50, v50 row_ror:2 row_mask:0xf bank_mask:0xf
  v_add_f32_dpp v51, v51, v51 row_ror:2 row_mask:0xf bank_mask:0xf
  v_add_f32_dpp v48, v48, v48 row_ror:1 row_mask:0xf bank_mask:0xf
  v_add_f32_dpp v49, v49, v49 row_ror:1 row_mask:0xf bank_mask:0xf
  v_add_f32_dpp v50, v50, v50 row_ror:1 row_mask:0xf bank_mask:0xf
  v_add_f32_dpp v51, v51, v51 row_ror:1 row_mask:0xf bank_mask:0xf
  v_cvt_pk_bf16_f32 v16, v48, v49
  v_lshlrev_b32 v48, 16, v16
  v_and_b32 v49, 0xffff0000, v16
  v_mul_f32 v48, s68, v48
  v_mul_f32 v49, s68, v49
  v_cvt_pk_bf16_f32 v16, v48, v49
  v_lshlrev_b32 v48, 16, v16
  v_and_b32 v49, 0xffff0000, v16
  v_cvt_pk_bf16_f32 v16, v50, v51
  v_lshlrev_b32 v50, 16, v16
  v_and_b32 v51, 0xffff0000, v16
  v_mul_f32 v50, s68, v50
  v_mul_f32 v51, s68, v51
  v_cvt_pk_bf16_f32 v16, v50, v51
  v_lshlrev_b32 v50, 16, v16
  v_and_b32 v51, 0xffff0000, v16
  v_max3_f32 v8, v48, v49, v5
  v_max3_f32 v8, v50, v51, v8
  v_sub_f32 v9, v5, v8
  v_mul_f32 v10, s67, v8
  v_mul_f32 v9, s67, v9
  v_fma_f32 v12, v48, s67, -v10
  v_fma_f32 v13, v49, s67, -v10
  v_fma_f32 v14, v50, s67, -v10
  v_fma_f32 v15, v51, s67, -v10
  v_exp_f32 v9, v9
  v_exp_f32 v12, v12
  v_exp_f32 v13, v13
  v_exp_f32 v14, v14
  v_exp_f32 v15, v15
  v_mov_b32 v5, v8
  v_mul_f32 v40, v9, v40
  v_mul_f32 v41, v9, v41
  v_mul_f32 v42, v9, v42
  v_mul_f32 v43, v9, v43
  v_mul_f32 v44, v9, v44
  v_mul_f32 v45, v9, v45
  v_mul_f32 v46, v9, v46
  v_mul_f32 v47, v9, v47
  v_cvt_pk_bf16_f32 v18, v12, v13
  v_cvt_pk_bf16_f32 v19, v14, v15
  v_add_f32 v16, v12, v13
  v_add_f32 v17, v14, v15
  v_add_f32 v16, v16, v17
  v_fma_f32 v6, v6, v9, v16
  v_perm_b32 v20, v108, v104, s65
  v_perm_b32 v21, v108, v104, s66
  v_dot2_f32_bf16 v40, v20, v18, v40
  v_dot2_f32_bf16 v41, v21, v18, v41
  v_perm_b32 v22, v109, v105, s65
  v_perm_b32 v11, v109, v105, s66
  v_dot2_f32_bf16 v42, v22, v18, v42
  v_dot2_f32_bf16 v43, v11, v18, v43
  v_perm_b32 v20, v110, v106, s65
  v_perm_b32 v21, v110, v106, s66
  v_dot2_f32_bf16 v44, v20, v18, v44
  v_dot2_f32_bf16 v45, v21, v18, v45
  v_perm_b32 v22, v111, v107, s65
  v_perm_b32 v11, v111, v107, s66
  v_dot2_f32_bf16 v46, v22, v18, v46
  v_dot2_f32_bf16 v47, v11, v18, v47
  v_perm_b32 v20, v116, v112, s65
  v_perm_b32 v21, v116, v112, s66
  v_dot2_f32_bf16 v40, v20, v19, v40
  v_dot2_f32_bf16 v41, v21, v19, v41
  v_perm_b32 v22, v117, v113, s65
  v_perm_b32 v11, v117, v113, s66
  v_dot2_f32_bf16 v42, v22, v19, v42
  v_dot2_f32_bf16 v43, v11, v19, v43
  v_perm_b32 v20, v118, v114, s65
  v_perm_b32 v21, v118, v114, s66
  v_dot2_f32_bf16 v44, v20, v19, v44
  v_dot2_f32_bf16 v45, v21, v19, v45
  v_perm_b32 v22, v119, v115, s65
  v_perm_b32 v11, v119, v115, s66
  v_dot2_f32_bf16 v46, v22, v19, v46
  v_dot2_f32_bf16 v47, v11, v19, v47
  v_dot2_f32_bf16 v48, v120, v52, 0
  v_dot2_f32_bf16 v49, v124, v52, 0
  v_dot2_f32_bf16 v50, v128, v52, 0
  v_dot2_f32_bf16 v51, v132, v52, 0
  v_dot2_f32_bf16 v48, v121, v53, v48
  v_dot2_f32_bf16 v49, v125, v53, v49
  v_dot2_f32_bf16 v50, v129, v53, v50
  v_dot2_f32_bf16 v51, v133, v53, v51
  v_dot2_f32_bf16 v48, v122, v54, v48
  v_dot2_f32_bf16 v49, v126, v54, v49
  v_dot2_f32_bf16 v50, v130, v54, v50
  v_dot2_f32_bf16 v51, v134, v54, v51
  v_dot2_f32_bf16 v48, v123, v55, v48
  v_dot2_f32_bf16 v49, v127, v55, v49
  v_dot2_f32_bf16 v50, v131, v55, v50
  v_dot2_f32_bf16 v51, v135, v55, v51
  s_nop 0
  v_add_f32_dpp v48, v48, v48 row_ror:8 row_mask:0xf bank_mask:0xf
  v_add_f32_dpp v49, v49, v49 row_ror:8 row_mask:0xf bank_mask:0xf
  v_add_f32_dpp v50, v50, v50 row_ror:8 row_mask:0xf bank_mask:0xf
  v_add_f32_dpp v51, v51, v51 row_ror:8 row_mask:0xf bank_mask:0xf
  v_add_f32_dpp v48, v48, v48 row_ror:4 row_mask:0xf bank_mask:0xf
  v_add_f32_dpp v49, v49, v49 row_ror:4 row_mask:0xf bank_mask:0xf
  v_add_f32_dpp v50, v50, v50 row_ror:4 row_mask:0xf bank_mask:0xf
  v_add_f32_dpp v51, v51, v51 row_ror:4 row_mask:0xf bank_mask:0xf
  v_add_f32_dpp v48, v48, v48 row_ror:2 row_mask:0xf bank_mask:0xf
  v_add_f32_dpp v49, v49, v49 row_ror:2 row_mask:0xf bank_mask:0xf
  v_add_f32_dpp v50, v50, v50 row_ror:2 row_mask:0xf bank_mask:0xf
  v_add_f32_dpp v51, v51, v51 row_ror:2 row_mask:0xf bank_mask:0xf
  v_add_f32_dpp v48, v48, v48 row_ror:1 row_mask:0xf bank_mask:0xf
  v_add_f32_dpp v49, v49, v49 row_ror:1 row_mask:0xf bank_mask:0xf
  v_add_f32_dpp v50, v50, v50 row_ror:1 row_mask:0xf bank_mask:0xf
  v_add_f32_dpp v51, v51, v51 row_ror:1 row_mask:0xf bank_mask:0xf
  v_cvt_pk_bf16_f32 v16, v48, v49
  v_lshlrev_b32 v48, 16, v16
  v_and_b32 v49, 0xffff0000, v16
  v_mul_f32 v48, s68, v48
  v_mul_f32 v49, s68, v49
  v_cvt_pk_bf16_f32 v16, v48, v49
  v_lshlrev_b32 v48, 16, v16
  v_and_b32 v49, 0xffff0000, v16
  v_cvt_pk_bf16_f32 v16, v50, v51
  v_lshlrev_b32 v50, 16, v16
  v_and_b32 v51, 0xffff0000, v16
  v_mul_f32 v50, s68, v50
  v_mul_f32 v51, s68, v51
  v_cvt_pk_bf16_f32 v16, v50, v51
  v_lshlrev_b32 v50, 16, v16
  v_and_b32 v51, 0xffff0000, v16
  v_max3_f32 v8, v48, v49, v5
  v_max3_f32 v8, v50, v51, v8
  v_sub_f32 v9, v5, v8
  v_mul_f32 v10, s67, v8
  v_mul_f32 v9, s67, v9
  v_fma_f32 v12, v48, s67, -v10
  v_fma_f32 v13, v49, s67, -v10
  v_fma_f32 v14, v50, s67, -v10
  v_fma_f32 v15, v51, s67, -v10
  v_exp_f32 v9, v9
  v_exp_f32 v12, v12
  v_exp_f32 v13, v13
  v_exp_f32 v14, v14
  v_exp_f32 v15, v15
  v_mov_b32 v5, v8
  v_mul_f32 v40, v9, v40
  v_mul_f32 v41, v9, v41
  v_mul_f32 v42, v9, v42
  v_mul_f32 v43, v9, v43
  v_mul_f32 v44, v9, v44
  v_mul_f32 v45, v9, v45
  v_mul_f32 v46, v9, v46
  v_mul_f32 v47, v9, v47
  v_cvt_pk_bf16_f32 v18, v12, v13
  v_cvt_pk_bf16_f32 v19, v14, v15
  v_add_f32 v16, v12, v13
  v_add_f32 v17, v14, v15
  v_add_f32 v16, v16, v17
  v_fma_f32 v6, v6, v9, v16
  v_perm_b32 v20, v140, v136, s65
  v_perm_b32 v21, v140, v136, s66
  v_dot2_f32_bf16 v40, v20, v18, v40
  v_dot2_f32_bf16 v41, v21, v18, v41
  v_perm_b32 v22, v141, v137, s65
  v_perm_b32 v11, v141, v137, s66
  v_dot2_f32_bf16 v42, v22, v18, v42
  v_dot2_f32_bf16 v43, v11, v18, v43
  v_perm_b32 v20, v142, v138, s65
  v_perm_b32 v21, v142, v138, s66
  v_dot2_f32_bf16 v44, v20, v18, v44
  v_dot2_f32_bf16 v45, v21, v18, v45
  v_perm_b32 v22, v143, v139, s65
  v_perm_b32 v11, v143, v139, s66
  v_dot2_f32_bf16 v46, v22, v18, v46
  v_dot2_f32_bf16 v47, v11, v18, v47
  v_perm_b32 v20, v148, v144, s65
  v_perm_b32 v21, v148, v144, s66
  v_dot2_f32_bf16 v40, v20, v19, v40
  v_dot2_f32_bf16 v41, v21, v19, v41
  v_perm_b32 v22, v149, v145, s65
  v_perm_b32 v11, v149, v145, s66
  v_dot2_f32_bf16 v42, v22, v19, v42
  v_dot2_f32_bf16 v43, v11, v19, v43
  v_perm_b32 v20, v150, v146, s65
  v_perm_b32 v21, v150, v146, s66
  v_dot2_f32_bf16 v44, v20, v19, v44
  v_dot2_f32_bf16 v45, v21, v19, v45
  v_perm_b32 v22, v151, v147, s65
  v_perm_b32 v11, v151, v147, s66
  v_dot2_f32_bf16 v46, v22, v19, v46
  v_dot2_f32_bf16 v47, v11, v19, v47
  s_waitcnt vmcnt(12)
  v_dot2_f32_bf16 v48, v152, v52, 0
  v_dot2_f32_bf16 v49, v156, v52, 0
  v_dot2_f32_bf16 v50, v160, v52, 0
  v_dot2_f32_bf16 v51, v164, v52, 0
  v_dot2_f32_bf16 v48, v153, v53, v48
  v_dot2_f32_bf16 v49, v157, v53, v49
  v_dot2_f32_bf16 v50, v161, v53, v50
  v_dot2_f32_bf16 v51, v165, v53, v51
  v_dot2_f32_bf16 v48, v154, v54, v48
  v_dot2_f32_bf16 v49, v158, v54, v49
  v_dot2_f32_bf16 v50, v162, v54, v50
  v_dot2_f32_bf16 v51, v166, v54, v51
  v_dot2_f32_bf16 v48, v155, v55, v48
  v_dot2_f32_bf16 v49, v159, v55, v49
  v_dot2_f32_bf16 v50, v163, v55, v50
  v_dot2_f32_bf16 v51, v167, v55, v51
  s_nop 0
  v_add_f32_dpp v48, v48, v48 row_ror:8 row_mask:0xf bank_mask:0xf
  v_add_f32_dpp v49, v49, v49 row_ror:8 row_mask:0xf bank_mask:0xf
  v_add_f32_dpp v50, v50, v50 row_ror:8 row_mask:0xf bank_mask:0xf
  v_add_f32_dpp v51, v51, v51 row_ror:8 row_mask:0xf bank_mask:0xf
  v_add_f32_dpp v48, v48, v48 row_ror:4 row_mask:0xf bank_mask:0xf
  v_add_f32_dpp v49, v49, v49 row_ror:4 row_mask:0xf bank_mask:0xf
  v_add_f32_dpp v50, v50, v50 row_ror:4 row_mask:0xf bank_mask:0xf
  v_add_f32_dpp v51, v51, v51 row_ror:4 row_mask:0xf bank_mask:0xf
  v_add_f32_dpp v48, v48, v48 row_ror:2 row_mask:0xf bank_mask:0xf
  v_add_f32_dpp v49, v49, v49 row_ror:2 row_mask:0xf bank_mask:0xf
  v_add_f32_dpp v50, v50, v50 row_ror:2 row_mask:0xf bank_mask:0xf
  v_add_f32_dpp v51, v51, v51 row_ror:2 row_mask:0xf bank_mask:0xf
  v_add_f32_dpp v48, v48, v48 row_ror:1 row_mask:0xf bank_mask:0xf
  v_add_f32_dpp v49, v49, v49 row_ror:1 row_mask:0xf bank_mask:0xf
  v_add_f32_dpp v50, v50, v50 row_ror:1 row_mask:0xf bank_mask:0xf
  v_add_f32_dpp v51, v51, v51 row_ror:1 row_mask:0xf bank_mask:0xf
  s_waitcnt vmcnt(8)
  v_cvt_pk_bf16_f32 v16, v48, v49
  v_lshlrev_b32 v48, 16, v16
  v_and_b32 v49, 0xffff0000, v16
  v_mul_f32 v48, s68, v48
  v_mul_f32 v49, s68, v49
  v_cvt_pk_bf16_f32 v16, v48, v49
  v_lshlrev_b32 v48, 16, v16
  v_and_b32 v49, 0xffff0000, v16
  v_cvt_pk_bf16_f32 v16, v50, v51
  v_lshlrev_b32 v50, 16, v16
  v_and_b32 v51, 0xffff0000, v16
  v_mul_f32 v50, s68, v50
  v_mul_f32 v51, s68, v51
  v_cvt_pk_bf16_f32 v16, v50, v51
  v_lshlrev_b32 v50, 16, v16
  v_and_b32 v51, 0xffff0000, v16
  v_max3_f32 v8, v48, v49, v5
  v_max3_f32 v8, v50, v51, v8
  v_sub_f32 v9, v5, v8
  v_mul_f32 v10, s67, v8
  v_mul_f32 v9, s67, v9
  v_fma_f32 v12, v48, s67, -v10
  v_fma_f32 v13, v49, s67, -v10
  v_fma_f32 v14, v50, s67, -v10
  v_fma_f32 v15, v51, s67, -v10
  v_exp_f32 v9, v9
  v_exp_f32 v12, v12
  v_exp_f32 v13, v13
  v_exp_f32 v14, v14
  v_exp_f32 v15, v15
  v_mov_b32 v5, v8
  v_mul_f32 v40, v9, v40
  v_mul_f32 v41, v9, v41
  v_mul_f32 v42, v9, v42
  v_mul_f32 v43, v9, v43
  v_mul_f32 v44, v9, v44
  v_mul_f32 v45, v9, v45
  v_mul_f32 v46, v9, v46
  v_mul_f32 v47, v9, v47
  v_cvt_pk_bf16_f32 v18, v12, v13
  v_cvt_pk_bf16_f32 v19, v14, v15
  v_add_f32 v16, v12, v13
  v_add_f32 v17, v14, v15
  v_add_f32 v16, v16, v17
  v_fma_f32 v6, v6, v9, v16
  v_perm_b32 v20, v172, v168, s65
  v_perm_b32 v21, v172, v168, s66
  v_dot2_f32_bf16 v40, v20, v18, v40
  v_dot2_f32_bf16 v41, v21, v18, v41
  v_perm_b32 v22, v173, v169, s65
  v_perm_b32 v11, v173, v169, s66
  v_dot2_f32_bf16 v42, v22, v18, v42
  v_dot2_f32_bf16 v43, v11, v18, v43
  v_perm_b32 v20, v174, v170, s65
  v_perm_b32 v21, v174, v170, s66
  v_dot2_f32_bf16 v44, v20, v18, v44
  v_dot2_f32_bf16 v45, v21, v18, v45
  v_perm_b32 v22, v175, v171, s65
  v_perm_b32 v11, v175, v171, s66
  v_dot2_f32_bf16 v46, v22, v18, v46
  v_dot2_f32_bf16 v47, v11, v18, v47
  v_perm_b32 v20, v180, v176, s65
  v_perm_b32 v21, v180, v176, s66
  v_dot2_f32_bf16 v40, v20, v19, v40
  v_dot2_f32_bf16 v41, v21, v19, v41
  v_perm_b32 v22, v181, v177, s65
  v_perm_b32 v11, v181, v177, s66
  v_dot2_f32_bf16 v42, v22, v19, v42
  v_dot2_f32_bf16 v43, v11, v19, v43
  v_perm_b32 v20, v182, v178, s65
  v_perm_b32 v21, v182, v178, s66
  v_dot2_f32_bf16 v44, v20, v19, v44
  v_dot2_f32_bf16 v45, v21, v19, v45
  v_perm_b32 v22, v183, v179, s65
  v_perm_b32 v11, v183, v179, s66
  v_dot2_f32_bf16 v46, v22, v19, v46
  v_dot2_f32_bf16 v47, v11, v19, v47
  s_waitcnt vmcnt(4)
  v_dot2_f32_bf16 v48, v184, v52, 0
  v_dot2_f32_bf16 v49, v188, v52, 0
  v_dot2_f32_bf16 v50, v192, v52, 0
  v_dot2_f32_bf16 v51, v196, v52, 0
  v_dot2_f32_bf16 v48, v185, v53, v48
  v_dot2_f32_bf16 v49, v189, v53, v49
  v_dot2_f32_bf16 v50, v193, v53, v50
  v_dot2_f32_bf16 v51, v197, v53, v51
  v_dot2_f32_bf16 v48, v186, v54, v48
  v_dot2_f32_bf16 v49, v190, v54, v49
  v_dot2_f32_bf16 v50, v194, v54, v50
  v_dot2_f32_bf16 v51, v198, v54, v51
  v_dot2_f32_bf16 v48, v187, v55, v48
  v_dot2_f32_bf16 v49, v191, v55, v49
  v_dot2_f32_bf16 v50, v195, v55, v50
  v_dot2_f32_bf16 v51, v199, v55, v51
  s_nop 0
  v_add_f32_dpp v48, v48, v48 row_ror:8 row_mask:0xf bank_mask:0xf
  v_add_f32_dpp v49, v49, v49 row_ror:8 row_mask:0xf bank_mask:0xf
  v_add_f32_dpp v50, v50, v50 row_ror:8 row_mask:0xf bank_mask:0xf
  v_add_f32_dpp v51, v51, v51 row_ror:8 row_mask:0xf bank_mask:0xf
  v_add_f32_dpp v48, v48, v48 row_ror:4 row_mask:0xf bank_mask:0xf
  v_add_f32_dpp v49, v49, v49 row_ror:4 row_mask:0xf bank_mask:0xf
  v_add_f32_dpp v50, v50, v50 row_ror:4 row_mask:0xf bank_mask:0xf
  v_add_f32_dpp v51, v51, v51 row_ror:4 row_mask:0xf bank_mask:0xf
  v_add_f32_dpp v48, v48, v48 row_ror:2 row_mask:0xf bank_mask:0xf
  v_add_f32_dpp v49, v49, v49 row_ror:2 row_mask:0xf bank_mask:0xf
  v_add_f32_dpp v50, v50, v50 row_ror:2 row_mask:0xf bank_mask:0xf
  v_add_f32_dpp v51, v51, v51 row_ror:2 row_mask:0xf bank_mask:0xf
  v_add_f32_dpp v48, v48, v48 row_ror:1 row_mask:0xf bank_mask:0xf
  v_add_f32_dpp v49, v49, v49 row_ror:1 row_mask:0xf bank_mask:0xf
  v_add_f32_dpp v50, v50, v50 row_ror:1 row_mask:0xf bank_mask:0xf
  v_add_f32_dpp v51, v51, v51 row_ror:1 row_mask:0xf bank_mask:0xf
  s_waitcnt vmcnt(0)
  v_cvt_pk_bf16_f32 v16, v48, v49
  v_lshlrev_b32 v48, 16, v16
  v_and_b32 v49, 0xffff0000, v16
  v_mul_f32 v48, s68, v48
  v_mul_f32 v49, s68, v49
  v_cvt_pk_bf16_f32 v16, v48, v49
  v_lshlrev_b32 v48, 16, v16
  v_and_b32 v49, 0xffff0000, v16
  v_cvt_pk_bf16_f32 v16, v50, v51
  v_lshlrev_b32 v50, 16, v16
  v_and_b32 v51, 0xffff0000, v16
  v_mul_f32 v50, s68, v50
  v_mul_f32 v51, s68, v51
  v_cvt_pk_bf16_f32 v16, v50, v51
  v_lshlrev_b32 v50, 16, v16
  v_and_b32 v51, 0xffff0000, v16
  v_max3_f32 v8, v48, v49, v5
  v_max3_f32 v8, v50, v51, v8
  v_sub_f32 v9, v5, v8
  v_mul_f32 v10, s67, v8
  v_mul_f32 v9, s67, v9
  v_fma_f32 v12, v48, s67, -v10
  v_fma_f32 v13, v49, s67, -v10
  v_fma_f32 v14, v50, s67, -v10
  v_fma_f32 v15, v51, s67, -v10
  v_exp_f32 v9, v9
  v_exp_f32 v12, v12
  v_exp_f32 v13, v13
  v_exp_f32 v14, v14
  v_exp_f32 v15, v15
  v_mov_b32 v5, v8
  v_mul_f32 v40, v9, v40
  v_mul_f32 v41, v9, v41
  v_mul_f32 v42, v9, v42
  v_mul_f32 v43, v9, v43
  v_mul_f32 v44, v9, v44
  v_mul_f32 v45, v9, v45
  v_mul_f32 v46, v9, v46
  v_mul_f32 v47, v9, v47
  v_cvt_pk_bf16_f32 v18, v12, v13
  v_cvt_pk_bf16_f32 v19, v14, v15
  v_add_f32 v16, v12, v13
  v_add_f32 v17, v14, v15
  v_add_f32 v16, v16, v17
  v_fma_f32 v6, v6, v9, v16
  v_perm_b32 v20, v204, v200, s65
  v_perm_b32 v21, v204, v200, s66
  v_dot2_f32_bf16 v40, v20, v18, v40
  v_dot2_f32_bf16 v41, v21, v18, v41
  v_perm_b32 v22, v205, v201, s65
  v_perm_b32 v11, v205, v201, s66
  v_dot2_f32_bf16 v42, v22, v18, v42
  v_dot2_f32_bf16 v43, v11, v18, v43
  v_perm_b32 v20, v206, v202, s65
  v_perm_b32 v21, v206, v202, s66
  v_dot2_f32_bf16 v44, v20, v18, v44
  v_dot2_f32_bf16 v45, v21, v18, v45
  v_perm_b32 v22, v207, v203, s65
  v_perm_b32 v11, v207, v203, s66
  v_dot2_f32_bf16 v46, v22, v18, v46
  v_dot2_f32_bf16 v47, v11, v18, v47
  v_perm_b32 v20, v212, v208, s65
  v_perm_b32 v21, v212, v208, s66
  v_dot2_f32_bf16 v40, v20, v19, v40
  v_dot2_f32_bf16 v41, v21, v19, v41
  v_perm_b32 v22, v213, v209, s65
  v_perm_b32 v11, v213, v209, s66
  v_dot2_f32_bf16 v42, v22, v19, v42
  v_dot2_f32_bf16 v43, v11, v19, v43
  v_perm_b32 v20, v214, v210, s65
  v_perm_b32 v21, v214, v210, s66
  v_dot2_f32_bf16 v44, v20, v19, v44
  v_dot2_f32_bf16 v45, v21, v19, v45
  v_perm_b32 v22, v215, v211, s65
  v_perm_b32 v11, v215, v211, s66
  v_dot2_f32_bf16 v46, v22, v19, v46
  v_dot2_f32_bf16 v47, v11, v19, v47
  s_cmp_eq_u32 s3, 4
  s_cbranch_scc0 L1_yexit
  s_cmp_eq_u32 s88, 1
  s_cbranch_scc0 L1_yexit
  v_lshrrev_b32 v200, 2, v0
  v_and_b32 v201, 3, v0
  s_mov_b32 s61, 114688
  v_mul_lo_u32 v202, v200, s61
  v_lshl_add_u32 v202, v201, 4, v202
  v_lshlrev_b32 v8, 6, v200
  v_lshlrev_b32 v203, 4, v0
  buffer_load_dwordx4 v[152:155], v8, s[28:31], 0 offen offset:0
  buffer_load_dwordx4 v[156:159], v8, s[28:31], 0 offen offset:16
  buffer_load_dwordx4 v[160:163], v8, s[28:31], 0 offen offset:32
  buffer_load_dwordx4 v[164:167], v8, s[28:31], 0 offen offset:48
  buffer_load_dwordx4 v[168:171], v8, s[28:31], 0 offen offset:1024
  buffer_load_dwordx4 v[172:175], v8, s[28:31], 0 offen offset:1040
  buffer_load_dwordx4 v[176:179], v8, s[28:31], 0 offen offset:1056
  buffer_load_dwordx4 v[180:183], v8, s[28:31], 0 offen offset:1072
  s_lshl_b32 s69, s85, 6
  s_lshl_b32 s70, s85, 15
  s_add_u32 s61, s69, 0
  buffer_load_dwordx4 v[56:59], v202, s[52:55], s61 offen offset:0
  buffer_load_dwordx4 v[60:63], v202, s[52:55], s61 offen offset:3584
  s_add_u32 s61, s69, 7168
  buffer_load_dwordx4 v[64:67], v202, s[52:55], s61 offen offset:0
  buffer_load_dwordx4 v[68:71], v202, s[52:55], s61 offen offset:3584
  s_add_u32 s61, s69, 14336
  buffer_load_dwordx4 v[72:75], v202, s[52:55], s61 offen offset:0
  buffer_load_dwordx4 v[76:79], v202, s[52:55], s61 offen offset:3584
  s_add_u32 s61, s69, 21504
  buffer_load_dwordx4 v[80:83], v202, s[52:55], s61 offen offset:0
  buffer_load_dwordx4 v[84:87], v202, s[52:55], s61 offen offset:3584
  s_add_u32 s61, s69, 28672
  buffer_load_dwordx4 v[88:91], v202, s[52:55], s61 offen offset:0
  buffer_load_dwordx4 v[92:95], v202, s[52:55], s61 offen offset:3584
  s_add_u32 s61, s69, 35840
  buffer_load_dwordx4 v[96:99], v202, s[52:55], s61 offen offset:0
  buffer_load_dwordx4 v[100:103], v202, s[52:55], s61 offen offset:3584
  s_add_u32 s61, s69, 43008
  buffer_load_dwordx4 v[104:107], v202, s[52:55], s61 offen offset:0
  buffer_load_dwordx4 v[108:111], v202, s[52:55], s61 offen offset:3584
  s_add_u32 s61, s69, 50176
  buffer_load_dwordx4 v[112:115], v202, s[52:55], s61 offen offset:0
  buffer_load_dwordx4 v[116:119], v202, s[52:55], s61 offen offset:3584
  s_add_u32 s61, s69, 57344
  buffer_load_dwordx4 v[120:123], v202, s[52:55], s61 offen offset:0
  buffer_load_dwordx4 v[124:127], v202, s[52:55], s61 offen offset:3584
  s_add_u32 s61, s69, 64512
  buffer_load_dwordx4 v[128:131], v202, s[52:55], s61 offen offset:0
  buffer_load_dwordx4 v[132:135], v202, s[52:55], s61 offen offset:3584
  s_add_u32 s61, s69, 71680
  buffer_load_dwordx4 v[136:139], v202, s[52:55], s61 offen offset:0
  buffer_load_dwordx4 v[140:143], v202, s[52:55], s61 offen offset:3584
  s_add_u32 s61, s69, 78848
  buffer_load_dwordx4 v[144:147], v202, s[52:55], s61 offen offset:0
  buffer_load_dwordx4 v[148:151], v202, s[52:55], s61 offen offset:3584
  v_mov_b32 v184, 0
  v_mov_b32 v185, 0
  v_mov_b32 v186, 0
  v_mov_b32 v187, 0
  v_mov_b32 v188, 0
  v_mov_b32 v189, 0
  v_mov_b32 v190, 0
  v_mov_b32 v191, 0
  v_mov_b32 v192, 0
  v_mov_b32 v193, 0
  v_mov_b32 v194, 0
  v_mov_b32 v195, 0
  v_mov_b32 v196, 0
  v_mov_b32 v197, 0
  v_mov_b32 v198, 0
  v_mov_b32 v199, 0
  s_waitcnt vmcnt(24)
  s_waitcnt vmcnt(16)
  v_perm_b32 v10, v60, v56, s65
  v_perm_b32 v11, v60, v56, s66
  v_dot2_f32_bf16 v184, v10, v152, v184
  v_dot2_f32_bf16 v185, v11, v152, v185
  v_dot2_f32_bf16 v192, v10, v168, v192
  v_dot2_f32_bf16 v193, v11, v168, v193
  v_perm_b32 v12, v61, v57, s65
  v_perm_b32 v13, v61, v57, s66
  v_dot2_f32_bf16 v186, v12, v152, v186
  v_dot2_f32_bf16 v187, v13, v152, v187
  v_dot2_f32_bf16 v194, v12, v168, v194
  v_dot2_f32_bf16 v195, v13, v168, v195
  v_perm_b32 v10, v62, v58, s65
  v_perm_b32 v11, v62, v58, s66
  v_dot2_f32_bf16 v188, v10, v152, v188
  v_dot2_f32_bf16 v189, v11, v152, v189
  v_dot2_f32_bf16 v196, v10, v168, v196
  v_dot2_f32_bf16 v197, v11, v168, v197
  v_perm_b32 v12, v63, v59, s65
  v_perm_b32 v13, v63, v59, s66
  v_dot2_f32_bf16 v190, v12, v152, v190
  v_dot2_f32_bf16 v191, v13, v152, v191
  v_dot2_f32_bf16 v198, v12, v168, v198
  v_dot2_f32_bf16 v199, v13, v168, v199
  v_perm_b32 v10, v68, v64, s65
  v_perm_b32 v11, v68, v64, s66
  v_dot2_f32_bf16 v184, v10, v153, v184
  v_dot2_f32_bf16 v185, v11, v153, v185
  v_dot2_f32_bf16 v192, v10, v169, v192
  v_dot2_f32_bf16 v193, v11, v169, v193
  v_perm_b32 v12, v69, v65, s65
  v_perm_b32 v13, v69, v65, s66
  v_dot2_f32_bf16 v186, v12, v153, v186
  v_dot2_f32_bf16 v187, v13, v153, v187
  v_dot2_f32_bf16 v194, v12, v169, v194
  v_dot2_f32_bf16 v195, v13, v169, v195
  v_perm_b32 v10, v70, v66, s65
  v_perm_b32 v11, v70, v66, s66
  v_dot2_f32_bf16 v188, v10, v153, v188
  v_dot2_f32_bf16 v189, v11, v153, v189
  v_dot2_f32_bf16 v196, v10, v169, v196
  v_dot2_f32_bf16 v197, v11, v169, v197
  v_perm_b32 v12, v71, v67, s65
  v_perm_b32 v13, v71, v67, s66
  v_dot2_f32_bf16 v190, v12, v153, v190
  v_dot2_f32_bf16 v191, v13, v153, v191
  v_dot2_f32_bf16 v198, v12, v169, v198
  v_dot2_f32_bf16 v199, v13, v169, v199
  v_perm_b32 v10, v76, v72, s65
  v_perm_b32 v11, v76, v72, s66
  v_dot2_f32_bf16 v184, v10, v154, v184
  v_dot2_f32_bf16 v185, v11, v154, v185
  v_dot2_f32_bf16 v192, v10, v170, v192
  v_dot2_f32_bf16 v193, v11, v170, v193
  v_perm_b32 v12, v77, v73, s65
  v_perm_b32 v13, v77, v73, s66
  v_dot2_f32_bf16 v186, v12, v154, v186
  v_dot2_f32_bf16 v187, v13, v154, v187
  v_dot2_f32_bf16 v194, v12, v170, v194
  v_dot2_f32_bf16 v195, v13, v170, v195
  v_perm_b32 v10, v78, v74, s65
  v_perm_b32 v11, v78, v74, s66
  v_dot2_f32_bf16 v188, v10, v154, v188
  v_dot2_f32_bf16 v189, v11, v154, v189
  v_dot2_f32_bf16 v196, v10, v170, v196
  v_dot2_f32_bf16 v197, v11, v170, v197
  v_perm_b32 v12, v79, v75, s65
  v_perm_b32 v13, v79, v75, s66
  v_dot2_f32_bf16 v190, v12, v154, v190
  v_dot2_f32_bf16 v191, v13, v154, v191
  v_dot2_f32_bf16 v198, v12, v170, v198
  v_dot2_f32_bf16 v199, v13, v170, v199
  v_perm_b32 v10, v84, v80, s65
  v_perm_b32 v11, v84, v80, s66
  v_dot2_f32_bf16 v184, v10, v155, v184
  v_dot2_f32_bf16 v185, v11, v155, v185
  v_dot2_f32_bf16 v192, v10, v171, v192
  v_dot2_f32_bf16 v193, v11, v171, v193
  v_perm_b32 v12, v85, v81, s65
  v_perm_b32 v13, v85, v81, s66
  v_dot2_f32_bf16 v186, v12, v155, v186
  v_dot2_f32_bf16 v187, v13, v155, v187
  v_dot2_f32_bf16 v194, v12, v171, v194
  v_dot2_f32_bf16 v195, v13, v171, v195
  v_perm_b32 v10, v86, v82, s65
  v_perm_b32 v11, v86, v82, s66
  v_dot2_f32_bf16 v188, v10, v155, v188
  v_dot2_f32_bf16 v189, v11, v155, v189
  v_dot2_f32_bf16 v196, v10, v171, v196
  v_dot2_f32_bf16 v197, v11, v171, v197
  v_perm_b32 v12, v87, v83, s65
  v_perm_b32 v13, v87, v83, s66
  v_dot2_f32_bf16 v190, v12, v155, v190
  v_dot2_f32_bf16 v191, v13, v155, v191
  v_dot2_f32_bf16 v198, v12, v171, v198
  v_dot2_f32_bf16 v199, v13, v171, v199
  s_add_u32 s61, s69, 86016
  buffer_load_dwordx4 v[56:59], v202, s[52:55], s61 offen offset:0
  buffer_load_dwordx4 v[60:63], v202, s[52:55], s61 offen offset:3584
  s_add_u32 s61, s69, 93184
  buffer_load_dwordx4 v[64:67], v202, s[52:55], s61 offen offset:0
  buffer_load_dwordx4 v[68:71], v202, s[52:55], s61 offen offset:3584
  s_add_u32 s61, s69, 100352
  buffer_load_dwordx4 v[72:75], v202, s[52:55], s61 offen offset:0
  buffer_load_dwordx4 v[76:79], v202, s[52:55], s61 offen offset:3584
  s_add_u32 s61, s69, 107520
  buffer_load_dwordx4 v[80:83], v202, s[52:55], s61 offen offset:0
  buffer_load_dwordx4 v[84:87], v202, s[52:55], s61 offen offset:3584
  s_waitcnt vmcnt(16)
  v_perm_b32 v10, v92, v88, s65
  v_perm_b32 v11, v92, v88, s66
  v_dot2_f32_bf16 v184, v10, v156, v184
  v_dot2_f32_bf16 v185, v11, v156, v185
  v_dot2_f32_bf16 v192, v10, v172, v192
  v_dot2_f32_bf16 v193, v11, v172, v193
  v_perm_b32 v12, v93, v89, s65
  v_perm_b32 v13, v93, v89, s66
  v_dot2_f32_bf16 v186, v12, v156, v186
  v_dot2_f32_bf16 v187, v13, v156, v187
  v_dot2_f32_bf16 v194, v12, v172, v194
  v_dot2_f32_bf16 v195, v13, v172, v195
  v_perm_b32 v10, v94, v90, s65
  v_perm_b32 v11, v94, v90, s66
  v_dot2_f32_bf16 v188, v10, v156, v188
  v_dot2_f32_bf16 v189, v11, v156, v189
  v_dot2_f32_bf16 v196, v10, v172, v196
  v_dot2_f32_bf16 v197, v11, v172, v197
  v_perm_b32 v12, v95, v91, s65
  v_perm_b32 v13, v95, v91, s66
  v_dot2_f32_bf16 v190, v12, v156, v190
  v_dot2_f32_bf16 v191, v13, v156, v191
  v_dot2_f32_bf16 v198, v12, v172, v198
  v_dot2_f32_bf16 v199, v13, v172, v199
  v_perm_b32 v10, v100, v96, s65
  v_perm_b32 v11, v100, v96, s66
  v_dot2_f32_bf16 v184, v10, v157, v184
  v_dot2_f32_bf16 v185, v11, v157, v185
  v_dot2_f32_bf16 v192, v10, v173, v192
  v_dot2_f32_bf16 v193, v11, v173, v193
  v_perm_b32 v12, v101, v97, s65
  v_perm_b32 v13, v101, v97, s66
  v_dot2_f32_bf16 v186, v12, v157, v186
  v_dot2_f32_bf16 v187, v13, v157, v187
  v_dot2_f32_bf16 v194, v12, v173, v194
  v_dot2_f32_bf16 v195, v13, v173, v195
  v_perm_b32 v10, v102, v98, s65
  v_perm_b32 v11, v102, v98, s66
  v_dot2_f32_bf16 v188, v10, v157, v188
  v_dot2_f32_bf16 v189, v11, v157, v189
  v_dot2_f32_bf16 v196, v10, v173, v196
  v_dot2_f32_bf16 v197, v11, v173, v197
  v_perm_b32 v12, v103, v99, s65
  v_perm_b32 v13, v103, v99, s66
  v_dot2_f32_bf16 v190, v12, v157, v190
  v_dot2_f32_bf16 v191, v13, v157, v191
  v_dot2_f32_bf16 v198, v12, v173, v198
  v_dot2_f32_bf16 v199, v13, v173, v199
  v_perm_b32 v10, v108, v104, s65
  v_perm_b32 v11, v108, v104, s66
  v_dot2_f32_bf16 v184, v10, v158, v184
  v_dot2_f32_bf16 v185, v11, v158, v185
  v_dot2_f32_bf16 v192, v10, v174, v192
  v_dot2_f32_bf16 v193, v11, v174, v193
  v_perm_b32 v12, v109, v105, s65
  v_perm_b32 v13, v109, v105, s66
  v_dot2_f32_bf16 v186, v12, v158, v186
  v_dot2_f32_bf16 v187, v13, v158, v187
  v_dot2_f32_bf16 v194, v12, v174, v194
  v_dot2_f32_bf16 v195, v13, v174, v195
  v_perm_b32 v10, v110, v106, s65
  v_perm_b32 v11, v110, v106, s66
  v_dot2_f32_bf16 v188, v10, v158, v188
  v_dot2_f32_bf16 v189, v11, v158, v189
  v_dot2_f32_bf16 v196, v10, v174, v196
  v_dot2_f32_bf16 v197, v11, v174, v197
  v_perm_b32 v12, v111, v107, s65
  v_perm_b32 v13, v111, v107, s66
  v_dot2_f32_bf16 v190, v12, v158, v190
  v_dot2_f32_bf16 v191, v13, v158, v191
  v_dot2_f32_bf16 v198, v12, v174, v198
  v_dot2_f32_bf16 v199, v13, v174, v199
  v_perm_b32 v10, v116, v112, s65
  v_perm_b32 v11, v116, v112, s66
  v_dot2_f32_bf16 v184, v10, v159, v184
  v_dot2_f32_bf16 v185, v11, v159, v185
  v_dot2_f32_bf16 v192, v10, v175, v192
  v_dot2_f32_bf16 v193, v11, v175, v193
  v_perm_b32 v12, v117, v113, s65
  v_perm_b32 v13, v117, v113, s66
  v_dot2_f32_bf16 v186, v12, v159, v186
  v_dot2_f32_bf16 v187, v13, v159, v187
  v_dot2_f32_bf16 v194, v12, v175, v194
  v_dot2_f32_bf16 v195, v13, v175, v195
  v_perm_b32 v10, v118, v114, s65
  v_perm_b32 v11, v118, v114, s66
  v_dot2_f32_bf16 v188, v10, v159, v188
  v_dot2_f32_bf16 v189, v11, v159, v189
  v_dot2_f32_bf16 v196, v10, v175, v196
  v_dot2_f32_bf16 v197, v11, v175, v197
  v_perm_b32 v12, v119, v115, s65
  v_perm_b32 v13, v119, v115, s66
  v_dot2_f32_bf16 v190, v12, v159, v190
  v_dot2_f32_bf16 v191, v13, v159, v191
  v_dot2_f32_bf16 v198, v12, v175, v198
  v_dot2_f32_bf16 v199, v13, v175, v199
  s_add_u32 s61, s70, 0
  buffer_load_dwordx4 v[88:91], v203, s[56:59], s61 offen offset:0
  buffer_load_dwordx4 v[92:95], v203, s[56:59], s61 offen offset:1024
  buffer_load_dwordx4 v[96:99], v203, s[56:59], s61 offen offset:2048
  buffer_load_dwordx4 v[100:103], v203, s[56:59], s61 offen offset:3072
  s_add_u32 s61, s70, 4096
  buffer_load_dwordx4 v[104:107], v203, s[56:59], s61 offen offset:0
  buffer_load_dwordx4 v[108:111], v203, s[56:59], s61 offen offset:1024
  buffer_load_dwordx4 v[112:115], v203, s[56:59], s61 offen offset:2048
  buffer_load_dwordx4 v[116:119], v203, s[56:59], s61 offen offset:3072
  s_waitcnt vmcnt(16)
  v_perm_b32 v10, v124, v120, s65
  v_perm_b32 v11, v124, v120, s66
  v_dot2_f32_bf16 v184, v10, v160, v184
  v_dot2_f32_bf16 v185, v11, v160, v185
  v_dot2_f32_bf16 v192, v10, v176, v192
  v_dot2_f32_bf16 v193, v11, v176, v193
  v_perm_b32 v12, v125, v121, s65
  v_perm_b32 v13, v125, v121, s66
  v_dot2_f32_bf16 v186, v12, v160, v186
  v_dot2_f32_bf16 v187, v13, v160, v187
  v_dot2_f32_bf16 v194, v12, v176, v194
  v_dot2_f32_bf16 v195, v13, v176, v195
  v_perm_b32 v10, v126, v122, s65
  v_perm_b32 v11, v126, v122, s66
  v_dot2_f32_bf16 v188, v10, v160, v188
  v_dot2_f32_bf16 v189, v11, v160, v189
  v_dot2_f32_bf16 v196, v10, v176, v196
  v_dot2_f32_bf16 v197, v11, v176, v197
  v_perm_b32 v12, v127, v123, s65
  v_perm_b32 v13, v127, v123, s66
  v_dot2_f32_bf16 v190, v12, v160, v190
  v_dot2_f32_bf16 v191, v13, v160, v191
  v_dot2_f32_bf16 v198, v12, v176, v198
  v_dot2_f32_bf16 v199, v13, v176, v199
  v_perm_b32 v10, v132, v128, s65
  v_perm_b32 v11, v132, v128, s66
  v_dot2_f32_bf16 v184, v10, v161, v184
  v_dot2_f32_bf16 v185, v11, v161, v185
  v_dot2_f32_bf16 v192, v10, v177, v192
  v_dot2_f32_bf16 v193, v11, v177, v193
  v_perm_b32 v12, v133, v129, s65
  v_perm_b32 v13, v133, v129, s66
  v_dot2_f32_bf16 v186, v12, v161, v186
  v_dot2_f32_bf16 v187, v13, v161, v187
  v_dot2_f32_bf16 v194, v12, v177, v194
  v_dot2_f32_bf16 v195, v13, v177, v195
  v_perm_b32 v10, v134, v130, s65
  v_perm_b32 v11, v134, v130, s66
  v_dot2_f32_bf16 v188, v10, v161, v188
  v_dot2_f32_bf16 v189, v11, v161, v189
  v_dot2_f32_bf16 v196, v10, v177, v196
  v_dot2_f32_bf16 v197, v11, v177, v197
  v_perm_b32 v12, v135, v131, s65
  v_perm_b32 v13, v135, v131, s66
  v_dot2_f32_bf16 v190, v12, v161, v190
  v_dot2_f32_bf16 v191, v13, v161, v191
  v_dot2_f32_bf16 v198, v12, v177, v198
  v_dot2_f32_bf16 v199, v13, v177, v199
  v_perm_b32 v10, v140, v136, s65
  v_perm_b32 v11, v140, v136, s66
  v_dot2_f32_bf16 v184, v10, v162, v184
  v_dot2_f32_bf16 v185, v11, v162, v185
  v_dot2_f32_bf16 v192, v10, v178, v192
  v_dot2_f32_bf16 v193, v11, v178, v193
  v_perm_b32 v12, v141, v137, s65
  v_perm_b32 v13, v141, v137, s66
  v_dot2_f32_bf16 v186, v12, v162, v186
  v_dot2_f32_bf16 v187, v13, v162, v187
  v_dot2_f32_bf16 v194, v12, v178, v194
  v_dot2_f32_bf16 v195, v13, v178, v195
  v_perm_b32 v10, v142, v138, s65
  v_perm_b32 v11, v142, v138, s66
  v_dot2_f32_bf16 v188, v10, v162, v188
  v_dot2_f32_bf16 v189, v11, v162, v189
  v_dot2_f32_bf16 v196, v10, v178, v196
  v_dot2_f32_bf16 v197, v11, v178, v197
  v_perm_b32 v12, v143, v139, s65
  v_perm_b32 v13, v143, v139, s66
  v_dot2_f32_bf16 v190, v12, v162, v190
  v_dot2_f32_bf16 v191, v13, v162, v191
  v_dot2_f32_bf16 v198, v12, v178, v198
  v_dot2_f32_bf16 v199, v13, v178, v199
  v_perm_b32 v10, v148, v144, s65
  v_perm_b32 v11, v148, v144, s66
  v_dot2_f32_bf16 v184, v10, v163, v184
  v_dot2_f32_bf16 v185, v11, v163, v185
  v_dot2_f32_bf16 v192, v10, v179, v192
  v_dot2_f32_bf16 v193, v11, v179, v193
  v_perm_b32 v12, v149, v145, s65
  v_perm_b32 v13, v149, v145, s66
  v_dot2_f32_bf16 v186, v12, v163, v186
  v_dot2_f32_bf16 v187, v13, v163, v187
  v_dot2_f32_bf16 v194, v12, v179, v194
  v_dot2_f32_bf16 v195, v13, v179, v195
  v_perm_b32 v10, v150, v146, s65
  v_perm_b32 v11, v150, v146, s66
  v_dot2_f32_bf16 v188, v10, v163, v188
  v_dot2_f32_bf16 v189, v11, v163, v189
  v_dot2_f32_bf16 v196, v10, v179, v196
  v_dot2_f32_bf16 v197, v11, v179, v197
  v_perm_b32 v12, v151, v147, s65
  v_perm_b32 v13, v151, v147, s66
  v_dot2_f32_bf16 v190, v12, v163, v190
  v_dot2_f32_bf16 v191, v13, v163, v191
  v_dot2_f32_bf16 v198, v12, v179, v198
  v_dot2_f32_bf16 v199, v13, v179, v199
  s_add_u32 s61, s70, 8192
  buffer_load_dwordx4 v[120:123], v203, s[56:59], s61 offen offset:0
  buffer_load_dwordx4 v[124:127], v203, s[56:59], s61 offen offset:1024
  buffer_load_dwordx4 v[128:131], v203, s[56:59], s61 offen offset:2048
  buffer_load_dwordx4 v[132:135], v203, s[56:59], s61 offen offset:3072
  s_add_u32 s61, s70, 12288
  buffer_load_dwordx4 v[136:139], v203, s[56:59], s61 offen offset:0
  buffer_load_dwordx4 v[140:143], v203, s[56:59], s61 offen offset:1024
  buffer_load_dwordx4 v[144:147], v203, s[56:59], s61 offen offset:2048
  buffer_load_dwordx4 v[148:151], v203, s[56:59], s61 offen offset:3072
  s_waitcnt vmcnt(16)
  v_perm_b32 v10, v60, v56, s65
  v_perm_b32 v11, v60, v56, s66
  v_dot2_f32_bf16 v184, v10, v164, v184
  v_dot2_f32_bf16 v185, v11, v164, v185
  v_dot2_f32_bf16 v192, v10, v180, v192
  v_dot2_f32_bf16 v193, v11, v180, v193
  v_perm_b32 v12, v61, v57, s65
  v_perm_b32 v13, v61, v57, s66
  v_dot2_f32_bf16 v186, v12, v164, v186
  v_dot2_f32_bf16 v187, v13, v164, v187
  v_dot2_f32_bf16 v194, v12, v180, v194
  v_dot2_f32_bf16 v195, v13, v180, v195
  v_perm_b32 v10, v62, v58, s65
  v_perm_b32 v11, v62, v58, s66
  v_dot2_f32_bf16 v188, v10, v164, v188
  v_dot2_f32_bf16 v189, v11, v164, v189
  v_dot2_f32_bf16 v196, v10, v180, v196
  v_dot2_f32_bf16 v197, v11, v180, v197
  v_perm_b32 v12, v63, v59, s65
  v_perm_b32 v13, v63, v59, s66
  v_dot2_f32_bf16 v190, v12, v164, v190
  v_dot2_f32_bf16 v191, v13, v164, v191
  v_dot2_f32_bf16 v198, v12, v180, v198
  v_dot2_f32_bf16 v199, v13, v180, v199
  v_perm_b32 v10, v68, v64, s65
  v_perm_b32 v11, v68, v64, s66
  v_dot2_f32_bf16 v184, v10, v165, v184
  v_dot2_f32_bf16 v185, v11, v165, v185
  v_dot2_f32_bf16 v192, v10, v181, v192
  v_dot2_f32_bf16 v193, v11, v181, v193
  v_perm_b32 v12, v69, v65, s65
  v_perm_b32 v13, v69, v65, s66
  v_dot2_f32_bf16 v186, v12, v165, v186
  v_dot2_f32_bf16 v187, v13, v165, v187
  v_dot2_f32_bf16 v194, v12, v181, v194
  v_dot2_f32_bf16 v195, v13, v181, v195
  v_perm_b32 v10, v70, v66, s65
  v_perm_b32 v11, v70, v66, s66
  v_dot2_f32_bf16 v188, v10, v165, v188
  v_dot2_f32_bf16 v189, v11, v165, v189
  v_dot2_f32_bf16 v196, v10, v181, v196
  v_dot2_f32_bf16 v197, v11, v181, v197
  v_perm_b32 v12, v71, v67, s65
  v_perm_b32 v13, v71, v67, s66
  v_dot2_f32_bf16 v190, v12, v165, v190
  v_dot2_f32_bf16 v191, v13, v165, v191
  v_dot2_f32_bf16 v198, v12, v181, v198
  v_dot2_f32_bf16 v199, v13, v181, v199
  v_perm_b32 v10, v76, v72, s65
  v_perm_b32 v11, v76, v72, s66
  v_dot2_f32_bf16 v184, v10, v166, v184
  v_dot2_f32_bf16 v185, v11, v166, v185
  v_dot2_f32_bf16 v192, v10, v182, v192
  v_dot2_f32_bf16 v193, v11, v182, v193
  v_perm_b32 v12, v77, v73, s65
  v_perm_b32 v13, v77, v73, s66
  v_dot2_f32_bf16 v186, v12, v166, v186
  v_dot2_f32_bf16 v187, v13, v166, v187
  v_dot2_f32_bf16 v194, v12, v182, v194
  v_dot2_f32_bf16 v195, v13, v182, v195
  v_perm_b32 v10, v78, v74, s65
  v_perm_b32 v11, v78, v74, s66
  v_dot2_f32_bf16 v188, v10, v166, v188
  v_dot2_f32_bf16 v189, v11, v166, v189
  v_dot2_f32_bf16 v196, v10, v182, v196
  v_dot2_f32_bf16 v197, v11, v182, v197
  v_perm_b32 v12, v79, v75, s65
  v_perm_b32 v13, v79, v75, s66
  v_dot2_f32_bf16 v190, v12, v166, v190
  v_dot2_f32_bf16 v191, v13, v166, v191
  v_dot2_f32_bf16 v198, v12, v182, v198
  v_dot2_f32_bf16 v199, v13, v182, v199
  v_perm_b32 v10, v84, v80, s65
  v_perm_b32 v11, v84, v80, s66
  v_dot2_f32_bf16 v184, v10, v167, v184
  v_dot2_f32_bf16 v185, v11, v167, v185
  v_dot2_f32_bf16 v192, v10, v183, v192
  v_dot2_f32_bf16 v193, v11, v183, v193
  v_perm_b32 v12, v85, v81, s65
  v_perm_b32 v13, v85, v81, s66
  v_dot2_f32_bf16 v186, v12, v167, v186
  v_dot2_f32_bf16 v187, v13, v167, v187
  v_dot2_f32_bf16 v194, v12, v183, v194
  v_dot2_f32_bf16 v195, v13, v183, v195
  v_perm_b32 v10, v86, v82, s65
  v_perm_b32 v11, v86, v82, s66
  v_dot2_f32_bf16 v188, v10, v167, v188
  v_dot2_f32_bf16 v189, v11, v167, v189
  v_dot2_f32_bf16 v196, v10, v183, v196
  v_dot2_f32_bf16 v197, v11, v183, v197
  v_perm_b32 v12, v87, v83, s65
  v_perm_b32 v13, v87, v83, s66
  v_dot2_f32_bf16 v190, v12, v167, v190
  v_dot2_f32_bf16 v191, v13, v167, v191
  v_dot2_f32_bf16 v198, v12, v183, v198
  v_dot2_f32_bf16 v199, v13, v183, v199
  s_add_u32 s61, s70, 16384
  buffer_load_dwordx4 v[56:59], v203, s[56:59], s61 offen offset:0
  buffer_load_dwordx4 v[60:63], v203, s[56:59], s61 offen offset:1024
  buffer_load_dwordx4 v[64:67], v203, s[56:59], s61 offen offset:2048
  buffer_load_dwordx4 v[68:71], v203, s[56:59], s61 offen offset:3072
  s_add_u32 s61, s70, 20480
  buffer_load_dwordx4 v[72:75], v203, s[56:59], s61 offen offset:0
  buffer_load_dwordx4 v[76:79], v203, s[56:59], s61 offen offset:1024
  buffer_load_dwordx4 v[80:83], v203, s[56:59], s61 offen offset:2048
  buffer_load_dwordx4 v[84:87], v203, s[56:59], s61 offen offset:3072
  v_lshlrev_b32 v8, 8, v200
  v_lshl_add_u32 v8, v201, 5, v8
  v_add_u32 v8, 147456, v8
  s_nop 2
  ds_write_b128 v8, v[184:187] offset:0
  ds_write_b128 v8, v[188:191] offset:16
  ds_write_b128 v8, v[192:195] offset:128
  ds_write_b128 v8, v[196:199] offset:144
  v_lshlrev_b32 v9, 2, v0
  v_add_u32 v9, 147456, v9
  s_waitcnt lgkmcnt(0)
  ds_read_b32 v152, v9 offset:0
  ds_read_b32 v153, v9 offset:256
  ds_read_b32 v154, v9 offset:512
  ds_read_b32 v155, v9 offset:768
  ds_read_b32 v156, v9 offset:1024
  ds_read_b32 v157, v9 offset:1280
  ds_read_b32 v158, v9 offset:1536
  ds_read_b32 v159, v9 offset:1792
  ds_read_b32 v160, v9 offset:2048
  ds_read_b32 v161, v9 offset:2304
  ds_read_b32 v162, v9 offset:2560
  ds_read_b32 v163, v9 offset:2816
  ds_read_b32 v164, v9 offset:3072
  ds_read_b32 v165, v9 offset:3328
  ds_read_b32 v166, v9 offset:3584
  ds_read_b32 v167, v9 offset:3840
  s_waitcnt lgkmcnt(0)
  v_add_f32 v152, v152, v153
  v_add_f32 v154, v154, v155
  v_add_f32 v156, v156, v157
  v_add_f32 v158, v158, v159
  v_add_f32 v160, v160, v161
  v_add_f32 v162, v162, v163
  v_add_f32 v164, v164, v165
  v_add_f32 v166, v166, v167
  v_add_f32 v152, v152, v154
  v_add_f32 v156, v156, v158
  v_add_f32 v160, v160, v162
  v_add_f32 v164, v164, v166
  v_add_f32 v152, v152, v156
  v_add_f32 v160, v160, v164
  v_add_f32 v152, v152, v160
  v_cvt_pk_bf16_f32 v152, v152, v152
  v_lshlrev_b32 v152, 16, v152
  v_mul_f32 v153, 0xbfb8aa3b, v152
  v_exp_f32 v153, v153
  s_nop 0
  v_add_f32 v153, 1.0, v153
  v_rcp_f32 v153, v153
  s_nop 0
  v_mul_f32 v152, v152, v153
  v_cvt_pk_bf16_f32 v152, v152, v152
  v_lshlrev_b32 v9, 1, v0
  v_add_u32 v9, 151552, v9
  ds_write_b16 v9, v152
  v_mov_b32 v9, 151552
  s_waitcnt lgkmcnt(0)
  ds_read_b128 v[152:155], v9 offset:0
  ds_read_b128 v[156:159], v9 offset:16
  ds_read_b128 v[160:163], v9 offset:32
  ds_read_b128 v[164:167], v9 offset:48
  ds_read_b128 v[168:171], v9 offset:64
  ds_read_b128 v[172:175], v9 offset:80
  ds_read_b128 v[176:179], v9 offset:96
  ds_read_b128 v[180:183], v9 offset:112
  v_mov_b32 v184, 0
  v_mov_b32 v185, 0
  v_mov_b32 v186, 0
  v_mov_b32 v187, 0
  v_mov_b32 v188, 0
  v_mov_b32 v189, 0
  v_mov_b32 v190, 0
  v_mov_b32 v191, 0
  v_mov_b32 v192, 0
  v_mov_b32 v193, 0
  v_mov_b32 v194, 0
  v_mov_b32 v195, 0
  v_mov_b32 v196, 0
  v_mov_b32 v197, 0
  v_mov_b32 v198, 0
  v_mov_b32 v199, 0
  s_waitcnt lgkmcnt(0)
  s_waitcnt vmcnt(16)
  v_perm_b32 v10, v92, v88, s65
  v_perm_b32 v11, v92, v88, s66
  v_dot2_f32_bf16 v184, v10, v152, v184
  v_dot2_f32_bf16 v185, v11, v152, v185
  v_dot2_f32_bf16 v192, v10, v168, v192
  v_dot2_f32_bf16 v193, v11, v168, v193
  v_perm_b32 v12, v93, v89, s65
  v_perm_b32 v13, v93, v89, s66
  v_dot2_f32_bf16 v186, v12, v152, v186
  v_dot2_f32_bf16 v187, v13, v152, v187
  v_dot2_f32_bf16 v194, v12, v168, v194
  v_dot2_f32_bf16 v195, v13, v168, v195
  v_perm_b32 v10, v94, v90, s65
  v_perm_b32 v11, v94, v90, s66
  v_dot2_f32_bf16 v188, v10, v152, v188
  v_dot2_f32_bf16 v189, v11, v152, v189
  v_dot2_f32_bf16 v196, v10, v168, v196
  v_dot2_f32_bf16 v197, v11, v168, v197
  v_perm_b32 v12, v95, v91, s65
  v_perm_b32 v13, v95, v91, s66
  v_dot2_f32_bf16 v190, v12, v152, v190
  v_dot2_f32_bf16 v191, v13, v152, v191
  v_dot2_f32_bf16 v198, v12, v168, v198
  v_dot2_f32_bf16 v199, v13, v168, v199
  v_perm_b32 v10, v100, v96, s65
  v_perm_b32 v11, v100, v96, s66
  v_dot2_f32_bf16 v184, v10, v153, v184
  v_dot2_f32_bf16 v185, v11, v153, v185
  v_dot2_f32_bf16 v192, v10, v169, v192
  v_dot2_f32_bf16 v193, v11, v169, v193
  v_perm_b32 v12, v101, v97, s65
  v_perm_b32 v13, v101, v97, s66
  v_dot2_f32_bf16 v186, v12, v153, v186
  v_dot2_f32_bf16 v187, v13, v153, v187
  v_dot2_f32_bf16 v194, v12, v169, v194
  v_dot2_f32_bf16 v195, v13, v169, v195
  v_perm_b32 v10, v102, v98, s65
  v_perm_b32 v11, v102, v98, s66
  v_dot2_f32_bf16 v188, v10, v153, v188
  v_dot2_f32_bf16 v189, v11, v153, v189
  v_dot2_f32_bf16 v196, v10, v169, v196
  v_dot2_f32_bf16 v197, v11, v169, v197
  v_perm_b32 v12, v103, v99, s65
  v_perm_b32 v13, v103, v99, s66
  v_dot2_f32_bf16 v190, v12, v153, v190
  v_dot2_f32_bf16 v191, v13, v153, v191
  v_dot2_f32_bf16 v198, v12, v169, v198
  v_dot2_f32_bf16 v199, v13, v169, v199
  v_perm_b32 v10, v108, v104, s65
  v_perm_b32 v11, v108, v104, s66
  v_dot2_f32_bf16 v184, v10, v154, v184
  v_dot2_f32_bf16 v185, v11, v154, v185
  v_dot2_f32_bf16 v192, v10, v170, v192
  v_dot2_f32_bf16 v193, v11, v170, v193
  v_perm_b32 v12, v109, v105, s65
  v_perm_b32 v13, v109, v105, s66
  v_dot2_f32_bf16 v186, v12, v154, v186
  v_dot2_f32_bf16 v187, v13, v154, v187
  v_dot2_f32_bf16 v194, v12, v170, v194
  v_dot2_f32_bf16 v195, v13, v170, v195
  v_perm_b32 v10, v110, v106, s65
  v_perm_b32 v11, v110, v106, s66
  v_dot2_f32_bf16 v188, v10, v154, v188
  v_dot2_f32_bf16 v189, v11, v154, v189
  v_dot2_f32_bf16 v196, v10, v170, v196
  v_dot2_f32_bf16 v197, v11, v170, v197
  v_perm_b32 v12, v111, v107, s65
  v_perm_b32 v13, v111, v107, s66
  v_dot2_f32_bf16 v190, v12, v154, v190
  v_dot2_f32_bf16 v191, v13, v154, v191
  v_dot2_f32_bf16 v198, v12, v170, v198
  v_dot2_f32_bf16 v199, v13, v170, v199
  v_perm_b32 v10, v116, v112, s65
  v_perm_b32 v11, v116, v112, s66
  v_dot2_f32_bf16 v184, v10, v155, v184
  v_dot2_f32_bf16 v185, v11, v155, v185
  v_dot2_f32_bf16 v192, v10, v171, v192
  v_dot2_f32_bf16 v193, v11, v171, v193
  v_perm_b32 v12, v117, v113, s65
  v_perm_b32 v13, v117, v113, s66
  v_dot2_f32_bf16 v186, v12, v155, v186
  v_dot2_f32_bf16 v187, v13, v155, v187
  v_dot2_f32_bf16 v194, v12, v171, v194
  v_dot2_f32_bf16 v195, v13, v171, v195
  v_perm_b32 v10, v118, v114, s65
  v_perm_b32 v11, v118, v114, s66
  v_dot2_f32_bf16 v188, v10, v155, v188
  v_dot2_f32_bf16 v189, v11, v155, v189
  v_dot2_f32_bf16 v196, v10, v171, v196
  v_dot2_f32_bf16 v197, v11, v171, v197
  v_perm_b32 v12, v119, v115, s65
  v_perm_b32 v13, v119, v115, s66
  v_dot2_f32_bf16 v190, v12, v155, v190
  v_dot2_f32_bf16 v191, v13, v155, v191
  v_dot2_f32_bf16 v198, v12, v171, v198
  v_dot2_f32_bf16 v199, v13, v171, v199
  s_add_u32 s61, s70, 24576
  buffer_load_dwordx4 v[88:91], v203, s[56:59], s61 offen offset:0
  buffer_load_dwordx4 v[92:95], v203, s[56:59], s61 offen offset:1024
  buffer_load_dwordx4 v[96:99], v203, s[56:59], s61 offen offset:2048
  buffer_load_dwordx4 v[100:103], v203, s[56:59], s61 offen offset:3072
  s_add_u32 s61, s70, 28672
  buffer_load_dwordx4 v[104:107], v203, s[56:59], s61 offen offset:0
  buffer_load_dwordx4 v[108:111], v203, s[56:59], s61 offen offset:1024
  buffer_load_dwordx4 v[112:115], v203, s[56:59], s61 offen offset:2048
  buffer_load_dwordx4 v[116:119], v203, s[56:59], s61 offen offset:3072
  s_waitcnt vmcnt(16)
  v_perm_b32 v10, v124, v120, s65
  v_perm_b32 v11, v124, v120, s66
  v_dot2_f32_bf16 v184, v10, v156, v184
  v_dot2_f32_bf16 v185, v11, v156, v185
  v_dot2_f32_bf16 v192, v10, v172, v192
  v_dot2_f32_bf16 v193, v11, v172, v193
  v_perm_b32 v12, v125, v121, s65
  v_perm_b32 v13, v125, v121, s66
  v_dot2_f32_bf16 v186, v12, v156, v186
  v_dot2_f32_bf16 v187, v13, v156, v187
  v_dot2_f32_bf16 v194, v12, v172, v194
  v_dot2_f32_bf16 v195, v13, v172, v195
  v_perm_b32 v10, v126, v122, s65
  v_perm_b32 v11, v126, v122, s66
  v_dot2_f32_bf16 v188, v10, v156, v188
  v_dot2_f32_bf16 v189, v11, v156, v189
  v_dot2_f32_bf16 v196, v10, v172, v196
  v_dot2_f32_bf16 v197, v11, v172, v197
  v_perm_b32 v12, v127, v123, s65
  v_perm_b32 v13, v127, v123, s66
  v_dot2_f32_bf16 v190, v12, v156, v190
  v_dot2_f32_bf16 v191, v13, v156, v191
  v_dot2_f32_bf16 v198, v12, v172, v198
  v_dot2_f32_bf16 v199, v13, v172, v199
  v_perm_b32 v10, v132, v128, s65
  v_perm_b32 v11, v132, v128, s66
  v_dot2_f32_bf16 v184, v10, v157, v184
  v_dot2_f32_bf16 v185, v11, v157, v185
  v_dot2_f32_bf16 v192, v10, v173, v192
  v_dot2_f32_bf16 v193, v11, v173, v193
  v_perm_b32 v12, v133, v129, s65
  v_perm_b32 v13, v133, v129, s66
  v_dot2_f32_bf16 v186, v12, v157, v186
  v_dot2_f32_bf16 v187, v13, v157, v187
  v_dot2_f32_bf16 v194, v12, v173, v194
  v_dot2_f32_bf16 v195, v13, v173, v195
  v_perm_b32 v10, v134, v130, s65
  v_perm_b32 v11, v134, v130, s66
  v_dot2_f32_bf16 v188, v10, v157, v188
  v_dot2_f32_bf16 v189, v11, v157, v189
  v_dot2_f32_bf16 v196, v10, v173, v196
  v_dot2_f32_bf16 v197, v11, v173, v197
  v_perm_b32 v12, v135, v131, s65
  v_perm_b32 v13, v135, v131, s66
  v_dot2_f32_bf16 v190, v12, v157, v190
  v_dot2_f32_bf16 v191, v13, v157, v191
  v_dot2_f32_bf16 v198, v12, v173, v198
  v_dot2_f32_bf16 v199, v13, v173, v199
  v_perm_b32 v10, v140, v136, s65
  v_perm_b32 v11, v140, v136, s66
  v_dot2_f32_bf16 v184, v10, v158, v184
  v_dot2_f32_bf16 v185, v11, v158, v185
  v_dot2_f32_bf16 v192, v10, v174, v192
  v_dot2_f32_bf16 v193, v11, v174, v193
  v_perm_b32 v12, v141, v137, s65
  v_perm_b32 v13, v141, v137, s66
  v_dot2_f32_bf16 v186, v12, v158, v186
  v_dot2_f32_bf16 v187, v13, v158, v187
  v_dot2_f32_bf16 v194, v12, v174, v194
  v_dot2_f32_bf16 v195, v13, v174, v195
  v_perm_b32 v10, v142, v138, s65
  v_perm_b32 v11, v142, v138, s66
  v_dot2_f32_bf16 v188, v10, v158, v188
  v_dot2_f32_bf16 v189, v11, v158, v189
  v_dot2_f32_bf16 v196, v10, v174, v196
  v_dot2_f32_bf16 v197, v11, v174, v197
  v_perm_b32 v12, v143, v139, s65
  v_perm_b32 v13, v143, v139, s66
  v_dot2_f32_bf16 v190, v12, v158, v190
  v_dot2_f32_bf16 v191, v13, v158, v191
  v_dot2_f32_bf16 v198, v12, v174, v198
  v_dot2_f32_bf16 v199, v13, v174, v199
  v_perm_b32 v10, v148, v144, s65
  v_perm_b32 v11, v148, v144, s66
  v_dot2_f32_bf16 v184, v10, v159, v184
  v_dot2_f32_bf16 v185, v11, v159, v185
  v_dot2_f32_bf16 v192, v10, v175, v192
  v_dot2_f32_bf16 v193, v11, v175, v193
  v_perm_b32 v12, v149, v145, s65
  v_perm_b32 v13, v149, v145, s66
  v_dot2_f32_bf16 v186, v12, v159, v186
  v_dot2_f32_bf16 v187, v13, v159, v187
  v_dot2_f32_bf16 v194, v12, v175, v194
  v_dot2_f32_bf16 v195, v13, v175, v195
  v_perm_b32 v10, v150, v146, s65
  v_perm_b32 v11, v150, v146, s66
  v_dot2_f32_bf16 v188, v10, v159, v188
  v_dot2_f32_bf16 v189, v11, v159, v189
  v_dot2_f32_bf16 v196, v10, v175, v196
  v_dot2_f32_bf16 v197, v11, v175, v197
  v_perm_b32 v12, v151, v147, s65
  v_perm_b32 v13, v151, v147, s66
  v_dot2_f32_bf16 v190, v12, v159, v190
  v_dot2_f32_bf16 v191, v13, v159, v191
  v_dot2_f32_bf16 v198, v12, v175, v198
  v_dot2_f32_bf16 v199, v13, v175, v199
  s_waitcnt vmcnt(8)
  v_perm_b32 v10, v60, v56, s65
  v_perm_b32 v11, v60, v56, s66
  v_dot2_f32_bf16 v184, v10, v160, v184
  v_dot2_f32_bf16 v185, v11, v160, v185
  v_dot2_f32_bf16 v192, v10, v176, v192
  v_dot2_f32_bf16 v193, v11, v176, v193
  v_perm_b32 v12, v61, v57, s65
  v_perm_b32 v13, v61, v57, s66
  v_dot2_f32_bf16 v186, v12, v160, v186
  v_dot2_f32_bf16 v187, v13, v160, v187
  v_dot2_f32_bf16 v194, v12, v176, v194
  v_dot2_f32_bf16 v195, v13, v176, v195
  v_perm_b32 v10, v62, v58, s65
  v_perm_b32 v11, v62, v58, s66
  v_dot2_f32_bf16 v188, v10, v160, v188
  v_dot2_f32_bf16 v189, v11, v160, v189
  v_dot2_f32_bf16 v196, v10, v176, v196
  v_dot2_f32_bf16 v197, v11, v176, v197
  v_perm_b32 v12, v63, v59, s65
  v_perm_b32 v13, v63, v59, s66
  v_dot2_f32_bf16 v190, v12, v160, v190
  v_dot2_f32_bf16 v191, v13, v160, v191
  v_dot2_f32_bf16 v198, v12, v176, v198
  v_dot2_f32_bf16 v199, v13, v176, v199
  v_perm_b32 v10, v68, v64, s65
  v_perm_b32 v11, v68, v64, s66
  v_dot2_f32_bf16 v184, v10, v161, v184
  v_dot2_f32_bf16 v185, v11, v161, v185
  v_dot2_f32_bf16 v192, v10, v177, v192
  v_dot2_f32_bf16 v193, v11, v177, v193
  v_perm_b32 v12, v69, v65, s65
  v_perm_b32 v13, v69, v65, s66
  v_dot2_f32_bf16 v186, v12, v161, v186
  v_dot2_f32_bf16 v187, v13, v161, v187
  v_dot2_f32_bf16 v194, v12, v177, v194
  v_dot2_f32_bf16 v195, v13, v177, v195
  v_perm_b32 v10, v70, v66, s65
  v_perm_b32 v11, v70, v66, s66
  v_dot2_f32_bf16 v188, v10, v161, v188
  v_dot2_f32_bf16 v189, v11, v161, v189
  v_dot2_f32_bf16 v196, v10, v177, v196
  v_dot2_f32_bf16 v197, v11, v177, v197
  v_perm_b32 v12, v71, v67, s65
  v_perm_b32 v13, v71, v67, s66
  v_dot2_f32_bf16 v190, v12, v161, v190
  v_dot2_f32_bf16 v191, v13, v161, v191
  v_dot2_f32_bf16 v198, v12, v177, v198
  v_dot2_f32_bf16 v199, v13, v177, v199
  v_perm_b32 v10, v76, v72, s65
  v_perm_b32 v11, v76, v72, s66
  v_dot2_f32_bf16 v184, v10, v162, v184
  v_dot2_f32_bf16 v185, v11, v162, v185
  v_dot2_f32_bf16 v192, v10, v178, v192
  v_dot2_f32_bf16 v193, v11, v178, v193
  v_perm_b32 v12, v77, v73, s65
  v_perm_b32 v13, v77, v73, s66
  v_dot2_f32_bf16 v186, v12, v162, v186
  v_dot2_f32_bf16 v187, v13, v162, v187
  v_dot2_f32_bf16 v194, v12, v178, v194
  v_dot2_f32_bf16 v195, v13, v178, v195
  v_perm_b32 v10, v78, v74, s65
  v_perm_b32 v11, v78, v74, s66
  v_dot2_f32_bf16 v188, v10, v162, v188
  v_dot2_f32_bf16 v189, v11, v162, v189
  v_dot2_f32_bf16 v196, v10, v178, v196
  v_dot2_f32_bf16 v197, v11, v178, v197
  v_perm_b32 v12, v79, v75, s65
  v_perm_b32 v13, v79, v75, s66
  v_dot2_f32_bf16 v190, v12, v162, v190
  v_dot2_f32_bf16 v191, v13, v162, v191
  v_dot2_f32_bf16 v198, v12, v178, v198
  v_dot2_f32_bf16 v199, v13, v178, v199
  v_perm_b32 v10, v84, v80, s65
  v_perm_b32 v11, v84, v80, s66
  v_dot2_f32_bf16 v184, v10, v163, v184
  v_dot2_f32_bf16 v185, v11, v163, v185
  v_dot2_f32_bf16 v192, v10, v179, v192
  v_dot2_f32_bf16 v193, v11, v179, v193
  v_perm_b32 v12, v85, v81, s65
  v_perm_b32 v13, v85, v81, s66
  v_dot2_f32_bf16 v186, v12, v163, v186
  v_dot2_f32_bf16 v187, v13, v163, v187
  v_dot2_f32_bf16 v194, v12, v179, v194
  v_dot2_f32_bf16 v195, v13, v179, v195
  v_perm_b32 v10, v86, v82, s65
  v_perm_b32 v11, v86, v82, s66
  v_dot2_f32_bf16 v188, v10, v163, v188
  v_dot2_f32_bf16 v189, v11, v163, v189
  v_dot2_f32_bf16 v196, v10, v179, v196
  v_dot2_f32_bf16 v197, v11, v179, v197
  v_perm_b32 v12, v87, v83, s65
  v_perm_b32 v13, v87, v83, s66
  v_dot2_f32_bf16 v190, v12, v163, v190
  v_dot2_f32_bf16 v191, v13, v163, v191
  v_dot2_f32_bf16 v198, v12, v179, v198
  v_dot2_f32_bf16 v199, v13, v179, v199
  s_waitcnt vmcnt(0)
  v_perm_b32 v10, v92, v88, s65
  v_perm_b32 v11, v92, v88, s66
  v_dot2_f32_bf16 v184, v10, v164, v184
  v_dot2_f32_bf16 v185, v11, v164, v185
  v_dot2_f32_bf16 v192, v10, v180, v192
  v_dot2_f32_bf16 v193, v11, v180, v193
  v_perm_b32 v12, v93, v89, s65
  v_perm_b32 v13, v93, v89, s66
  v_dot2_f32_bf16 v186, v12, v164, v186
  v_dot2_f32_bf16 v187, v13, v164, v187
  v_dot2_f32_bf16 v194, v12, v180, v194
  v_dot2_f32_bf16 v195, v13, v180, v195
  v_perm_b32 v10, v94, v90, s65
  v_perm_b32 v11, v94, v90, s66
  v_dot2_f32_bf16 v188, v10, v164, v188
  v_dot2_f32_bf16 v189, v11, v164, v189
  v_dot2_f32_bf16 v196, v10, v180, v196
  v_dot2_f32_bf16 v197, v11, v180, v197
  v_perm_b32 v12, v95, v91, s65
  v_perm_b32 v13, v95, v91, s66
  v_dot2_f32_bf16 v190, v12, v164, v190
  v_dot2_f32_bf16 v191, v13, v164, v191
  v_dot2_f32_bf16 v198, v12, v180, v198
  v_dot2_f32_bf16 v199, v13, v180, v199
  v_perm_b32 v10, v100, v96, s65
  v_perm_b32 v11, v100, v96, s66
  v_dot2_f32_bf16 v184, v10, v165, v184
  v_dot2_f32_bf16 v185, v11, v165, v185
  v_dot2_f32_bf16 v192, v10, v181, v192
  v_dot2_f32_bf16 v193, v11, v181, v193
  v_perm_b32 v12, v101, v97, s65
  v_perm_b32 v13, v101, v97, s66
  v_dot2_f32_bf16 v186, v12, v165, v186
  v_dot2_f32_bf16 v187, v13, v165, v187
  v_dot2_f32_bf16 v194, v12, v181, v194
  v_dot2_f32_bf16 v195, v13, v181, v195
  v_perm_b32 v10, v102, v98, s65
  v_perm_b32 v11, v102, v98, s66
  v_dot2_f32_bf16 v188, v10, v165, v188
  v_dot2_f32_bf16 v189, v11, v165, v189
  v_dot2_f32_bf16 v196, v10, v181, v196
  v_dot2_f32_bf16 v197, v11, v181, v197
  v_perm_b32 v12, v103, v99, s65
  v_perm_b32 v13, v103, v99, s66
  v_dot2_f32_bf16 v190, v12, v165, v190
  v_dot2_f32_bf16 v191, v13, v165, v191
  v_dot2_f32_bf16 v198, v12, v181, v198
  v_dot2_f32_bf16 v199, v13, v181, v199
  v_perm_b32 v10, v108, v104, s65
  v_perm_b32 v11, v108, v104, s66
  v_dot2_f32_bf16 v184, v10, v166, v184
  v_dot2_f32_bf16 v185, v11, v166, v185
  v_dot2_f32_bf16 v192, v10, v182, v192
  v_dot2_f32_bf16 v193, v11, v182, v193
  v_perm_b32 v12, v109, v105, s65
  v_perm_b32 v13, v109, v105, s66
  v_dot2_f32_bf16 v186, v12, v166, v186
  v_dot2_f32_bf16 v187, v13, v166, v187
  v_dot2_f32_bf16 v194, v12, v182, v194
  v_dot2_f32_bf16 v195, v13, v182, v195
  v_perm_b32 v10, v110, v106, s65
  v_perm_b32 v11, v110, v106, s66
  v_dot2_f32_bf16 v188, v10, v166, v188
  v_dot2_f32_bf16 v189, v11, v166, v189
  v_dot2_f32_bf16 v196, v10, v182, v196
  v_dot2_f32_bf16 v197, v11, v182, v197
  v_perm_b32 v12, v111, v107, s65
  v_perm_b32 v13, v111, v107, s66
  v_dot2_f32_bf16 v190, v12, v166, v190
  v_dot2_f32_bf16 v191, v13, v166, v191
  v_dot2_f32_bf16 v198, v12, v182, v198
  v_dot2_f32_bf16 v199, v13, v182, v199
  v_perm_b32 v10, v116, v112, s65
  v_perm_b32 v11, v116, v112, s66
  v_dot2_f32_bf16 v184, v10, v167, v184
  v_dot2_f32_bf16 v185, v11, v167, v185
  v_dot2_f32_bf16 v192, v10, v183, v192
  v_dot2_f32_bf16 v193, v11, v183, v193
  v_perm_b32 v12, v117, v113, s65
  v_perm_b32 v13, v117, v113, s66
  v_dot2_f32_bf16 v186, v12, v167, v186
  v_dot2_f32_bf16 v187, v13, v167, v187
  v_dot2_f32_bf16 v194, v12, v183, v194
  v_dot2_f32_bf16 v195, v13, v183, v195
  v_perm_b32 v10, v118, v114, s65
  v_perm_b32 v11, v118, v114, s66
  v_dot2_f32_bf16 v188, v10, v167, v188
  v_dot2_f32_bf16 v189, v11, v167, v189
  v_dot2_f32_bf16 v196, v10, v183, v196
  v_dot2_f32_bf16 v197, v11, v183, v197
  v_perm_b32 v12, v119, v115, s65
  v_perm_b32 v13, v119, v115, s66
  v_dot2_f32_bf16 v190, v12, v167, v190
  v_dot2_f32_bf16 v191, v13, v167, v191
  v_dot2_f32_bf16 v198, v12, v183, v198
  v_dot2_f32_bf16 v199, v13, v183, v199
  s_nop 2
  v_mov_b32 v120, v184
  v_mov_b32 v121, v185
  v_mov_b32 v122, v186
  v_mov_b32 v123, v187
  v_mov_b32 v124, v188
  v_mov_b32 v125, v189
  v_mov_b32 v126, v190
  v_mov_b32 v127, v191
  v_mov_b32 v128, v192
  v_mov_b32 v129, v193
  v_mov_b32 v130, v194
  v_mov_b32 v131, v195
  v_mov_b32 v132, v196
  v_mov_b32 v133, v197
  v_mov_b32 v134, v198
  v_mov_b32 v135, v199
  v_lshrrev_b32 v136, 1, v0
  v_lshlrev_b32 v136, 12, v136
  v_and_b32 v137, 1, v0
  v_lshl_add_u32 v136, v137, 5, v136
  s_mov_b32 s84, 1
L1_yexit:
  s_sub_u32 s61, s3, 4
  s_lshl_b32 s61, s61, 2
  v_mov_b32 v9, s61
L1_poll1:
  ds_read_b32 v8, v9 offset:8336
  s_waitcnt lgkmcnt(0)
  v_readfirstlane_b32 s61, v8
  s_cmp_eq_u32 s61, 1
  s_cbranch_scc1 L1_polled1
  s_sleep 8
  s_branch L1_poll1
L1_polled1:
  v_lshrrev_b32 v20, 2, v2
  v_lshl_add_u32 v20, v1, 3, v20
  v_lshlrev_b32 v20, 7, v20
  v_and_b32 v21, 3, v2
  v_lshl_add_u32 v20, v21, 3, v20
  v_add_u32 v20, s71, v20
  ds_read_b64_tr_b16 v[184:185], v20 offset:0
  ds_read_b64_tr_b16 v[186:187], v20 offset:512
  ds_read_b64_tr_b16 v[188:189], v20 offset:32
  ds_read_b64_tr_b16 v[190:191], v20 offset:544
  ds_read_b64_tr_b16 v[192:193], v20 offset:64
  ds_read_b64_tr_b16 v[194:195], v20 offset:576
  ds_read_b64_tr_b16 v[196:197], v20 offset:96
  ds_read_b64_tr_b16 v[198:199], v20 offset:608
  ds_read_b64_tr_b16 v[200:201], v20 offset:4096
  ds_read_b64_tr_b16 v[202:203], v20 offset:4608
  ds_read_b64_tr_b16 v[204:205], v20 offset:4128
  ds_read_b64_tr_b16 v[206:207], v20 offset:4640
  ds_read_b64_tr_b16 v[208:209], v20 offset:4160
  ds_read_b64_tr_b16 v[210:211], v20 offset:4672
  ds_read_b64_tr_b16 v[212:213], v20 offset:4192
  ds_read_b64_tr_b16 v[214:215], v20 offset:4704
  ds_read_b64_tr_b16 v[216:217], v20 offset:8192
  ds_read_b64_tr_b16 v[218:219], v20 offset:8704
  ds_read_b64_tr_b16 v[220:221], v20 offset:8224
  ds_read_b64_tr_b16 v[222:223], v20 offset:8736
  ds_read_b64_tr_b16 v[224:225], v20 offset:8256
  ds_read_b64_tr_b16 v[226:227], v20 offset:8768
  ds_read_b64_tr_b16 v[228:229], v20 offset:8288
  ds_read_b64_tr_b16 v[230:231], v20 offset:8800
  ds_read_b64_tr_b16 v[232:233], v20 offset:12288
  ds_read_b64_tr_b16 v[234:235], v20 offset:12800
  ds_read_b64_tr_b16 v[236:237], v20 offset:12320
  ds_read_b64_tr_b16 v[238:239], v20 offset:12832
  ds_read_b64_tr_b16 v[240:241], v20 offset:12352
  ds_read_b64_tr_b16 v[242:243], v20 offset:12864
  ds_read_b64_tr_b16 v[244:245], v20 offset:12384
  ds_read_b64_tr_b16 v[246:247], v20 offset:12896
  s_waitcnt lgkmcnt(0)
  s_mov_b32 s86, 1
  s_branch L1_comb
L1_pathA:
  s_setprio 3
  v_lshlrev_b32 v8, 6, v1
  s_lshl_b32 s61, s63, 10
  s_lshl_b32 s69, s3, 8
  s_add_u32 s61, s61, s69
  buffer_load_dwordx4 v[184:187], v8, s[28:31], s61 offen offset:0
  buffer_load_dwordx4 v[188:191], v8, s[28:31], s61 offen offset:16
  buffer_load_dwordx4 v[192:195], v8, s[28:31], s61 offen offset:32
  buffer_load_dwordx4 v[196:199], v8, s[28:31], s61 offen offset:48
  v_lshlrev_b32 v9, 4, v2
  v_lshl_add_u32 v9, v1, 18, v9
  s_add_u32 s61, s89, s3
  s_mov_b32 s15, s61
  s_lshl_b32 s83, s3, 20
  s_lshl_b32 s69, s62, 8
  s_add_u32 s83, s83, s69
  s_lshl_b32 s70, s3, 15
  s_add_u32 s70, s70, 16384
  s_add_u32 m0, s70, 0
  s_add_u32 s61, s83, 0
  buffer_load_dwordx4 v9, s[32:35], s61 offen lds
  s_add_u32 m0, s70, 1024
  s_add_u32 s61, s83, 8192
  buffer_load_dwordx4 v9, s[32:35], s61 offen lds
  s_add_u32 m0, s70, 2048
  s_add_u32 s61, s83, 16384
  buffer_load_dwordx4 v9, s[32:35], s61 offen lds
  s_add_u32 m0, s70, 3072
  s_add_u32 s61, s83, 24576
  buffer_load_dwordx4 v9, s[32:35], s61 offen lds
  s_add_u32 s61, s89, 16
  v_mov_b32 v14, s61
  v_mov_b32 v15, 0
  v_mov_b32 v16, 0
  v_mov_b32 v17, 0
  v_mov_b32 v18, 0
  v_mov_b32 v19, 0
  ds_write_b64 v249, v[14:15] offset:8328
  ds_write_b128 v249, v[16:19] offset:8336
  s_waitcnt lgkmcnt(0)
  s_barrier
  s_add_u32 m0, s70, 4096
  s_add_u32 s61, s83, 32768
  buffer_load_dwordx4 v9, s[32:35], s61 offen lds
  s_add_u32 m0, s70, 5120
  s_add_u32 s61, s83, 40960
  buffer_load_dwordx4 v9, s[32:35], s61 offen lds
  s_add_u32 m0, s70, 6144
  s_add_u32 s61, s83, 49152
  buffer_load_dwordx4 v9, s[32:35], s61 offen lds
  s_add_u32 m0, s70, 7168
  s_add_u32 s61, s83, 57344
  buffer_load_dwordx4 v9, s[32:35], s61 offen lds
  s_lshr_b32 s12, s15, 2
  s_lshl_b32 s13, s12, 2
  s_add_u32 s13, s13, s64
  s_sub_u32 s14, s12, s8
  s_add_u32 s14, s14, s9
  s_cmp_lt_u32 s12, s8
  s_cselect_b32 s13, s13, s14
  s_lshl_b32 s13, s13, 14
  s_and_b32 s12, s15, 3
  s_lshl_b32 s12, s12, 12
  s_add_u32 s13, s13, s12
  s_add_u32 s13, s13, s60
  s_cmp_lt_u32 s15, s10
  s_cselect_b32 s72, s13, 0x40000000
  s_add_u32 s15, s15, 4
  buffer_load_dwordx4 v[56:59], v4, s[36:39], s72 offen offset:0 nt
  buffer_load_dwordx4 v[60:63], v4, s[36:39], s72 offen offset:256 nt
  buffer_load_dwordx4 v[64:67], v4, s[36:39], s72 offen offset:512 nt
  buffer_load_dwordx4 v[68:71], v4, s[36:39], s72 offen offset:768 nt
  buffer_load_dwordx4 v[72:75], v4, s[40:43], s72 offen offset:0 nt
  buffer_load_dwordx4 v[76:79], v4, s[40:43], s72 offen offset:256 nt
  buffer_load_dwordx4 v[80:83], v4, s[40:43], s72 offen offset:512 nt
  buffer_load_dwordx4 v[84:87], v4, s[40:43], s72 offen offset:768 nt
  s_add_u32 m0, s70, 8192
  s_add_u32 s61, s83, 65536
  buffer_load_dwordx4 v9, s[32:35], s61 offen lds
  s_add_u32 m0, s70, 9216
  s_add_u32 s61, s83, 73728
  buffer_load_dwordx4 v9, s[32:35], s61 offen lds
  s_add_u32 m0, s70, 10240
  s_add_u32 s61, s83, 81920
  buffer_load_dwordx4 v9, s[32:35], s61 offen lds
  s_add_u32 m0, s70, 11264
  s_add_u32 s61, s83, 90112
  buffer_load_dwordx4 v9, s[32:35], s61 offen lds
  s_add_u32 m0, s70, 12288
  s_add_u32 s61, s83, 98304
  buffer_load_dwordx4 v9, s[32:35], s61 offen lds
  s_add_u32 m0, s70, 13312
  s_add_u32 s61, s83, 106496
  buffer_load_dwordx4 v9, s[32:35], s61 offen lds
  s_add_u32 m0, s70, 14336
  s_add_u32 s61, s83, 114688
  buffer_load_dwordx4 v9, s[32:35], s61 offen lds
  s_add_u32 m0, s70, 15360
  s_add_u32 s61, s83, 122880
  buffer_load_dwordx4 v9, s[32:35], s61 offen lds
  s_lshr_b32 s12, s15, 2
  s_lshl_b32 s13, s12, 2
  s_add_u32 s13, s13, s64
  s_sub_u32 s14, s12, s8
  s_add_u32 s14, s14, s9
  s_cmp_lt_u32 s12, s8
  s_cselect_b32 s13, s13, s14
  s_lshl_b32 s13, s13, 14
  s_and_b32 s12, s15, 3
  s_lshl_b32 s12, s12, 12
  s_add_u32 s13, s13, s12
  s_add_u32 s13, s13, s60
  s_cmp_lt_u32 s15, s10
  s_cselect_b32 s73, s13, 0x40000000
  s_add_u32 s15, s15, 4
  buffer_load_dwordx4 v[88:91], v4, s[36:39], s73 offen offset:0 nt
  buffer_load_dwordx4 v[92:95], v4, s[36:39], s73 offen offset:256 nt
  buffer_load_dwordx4 v[96:99], v4, s[36:39], s73 offen offset:512 nt
  buffer_load_dwordx4 v[100:103], v4, s[36:39], s73 offen offset:768 nt
  buffer_load_dwordx4 v[104:107], v4, s[40:43], s73 offen offset:0 nt
  buffer_load_dwordx4 v[108:111], v4, s[40:43], s73 offen offset:256 nt
  buffer_load_dwordx4 v[112:115], v4, s[40:43], s73 offen offset:512 nt
  buffer_load_dwordx4 v[116:119], v4, s[40:43], s73 offen offset:768 nt
  s_add_u32 m0, s70, 16384
  s_add_u32 s61, s83, 131072
  buffer_load_dwordx4 v9, s[32:35], s61 offen lds
  s_add_u32 m0, s70, 17408
  s_add_u32 s61, s83, 139264
  buffer_load_dwordx4 v9, s[32:35], s61 offen lds
  s_add_u32 m0, s70, 18432
  s_add_u32 s61, s83, 147456
  buffer_load_dwordx4 v9, s[32:35], s61 offen lds
  s_add_u32 m0, s70, 19456
  s_add_u32 s61, s83, 155648
  buffer_load_dwordx4 v9, s[32:35], s61 offen lds
  s_add_u32 m0, s70, 20480
  s_add_u32 s61, s83, 163840
  buffer_load_dwordx4 v9, s[32:35], s61 offen lds
  s_add_u32 m0, s70, 21504
  s_add_u32 s61, s83, 172032
  buffer_load_dwordx4 v9, s[32:35], s61 offen lds
  s_add_u32 m0, s70, 22528
  s_add_u32 s61, s83, 180224
  buffer_load_dwordx4 v9, s[32:35], s61 offen lds
  s_add_u32 m0, s70, 23552
  s_add_u32 s61, s83, 188416
  buffer_load_dwordx4 v9, s[32:35], s61 offen lds
  s_lshr_b32 s12, s15, 2
  s_lshl_b32 s13, s12, 2
  s_add_u32 s13, s13, s64
  s_sub_u32 s14, s12, s8
  s_add_u32 s14, s14, s9
  s_cmp_lt_u32 s12, s8
  s_cselect_b32 s13, s13, s14
  s_lshl_b32 s13, s13, 14
  s_and_b32 s12, s15, 3
  s_lshl_b32 s12, s12, 12
  s_add_u32 s13, s13, s12
  s_add_u32 s13, s13, s60
  s_cmp_lt_u32 s15, s10
  s_cselect_b32 s74, s13, 0x40000000
  s_add_u32 s15, s15, 4
  buffer_load_dwordx4 v[120:123], v4, s[36:39], s74 offen offset:0 nt
  buffer_load_dwordx4 v[124:127], v4, s[36:39], s74 offen offset:256 nt
  buffer_load_dwordx4 v[128:131], v4, s[36:39], s74 offen offset:512 nt
  buffer_load_dwordx4 v[132:135], v4, s[36:39], s74 offen offset:768 nt
  buffer_load_dwordx4 v[136:139], v4, s[40:43], s74 offen offset:0 nt
  buffer_load_dwordx4 v[140:143], v4, s[40:43], s74 offen offset:256 nt
  buffer_load_dwordx4 v[144:147], v4, s[40:43], s74 offen offset:512 nt
  buffer_load_dwordx4 v[148:151], v4, s[40:43], s74 offen offset:768 nt
  s_add_u32 m0, s70, 24576
  s_add_u32 s61, s83, 196608
  buffer_load_dwordx4 v9, s[32:35], s61 offen lds
  s_add_u32 m0, s70, 25600
  s_add_u32 s61, s83, 204800
  buffer_load_dwordx4 v9, s[32:35], s61 offen lds
  s_add_u32 m0, s70, 26624
  s_add_u32 s61, s83, 212992
  buffer_load_dwordx4 v9, s[32:35], s61 offen lds
  s_add_u32 m0, s70, 27648
  s_add_u32 s61, s83, 221184
  buffer_load_dwordx4 v9, s[32:35], s61 offen lds
  s_add_u32 m0, s70, 28672
  s_add_u32 s61, s83, 229376
  buffer_load_dwordx4 v9, s[32:35], s61 offen lds
  s_add_u32 m0, s70, 29696
  s_add_u32 s61, s83, 237568
  buffer_load_dwordx4 v9, s[32:35], s61 offen lds
  s_add_u32 m0, s70, 30720
  s_add_u32 s61, s83, 245760
  buffer_load_dwordx4 v9, s[32:35], s61 offen lds
  s_add_u32 m0, s70, 31744
  s_add_u32 s61, s83, 253952
  buffer_load_dwordx4 v9, s[32:35], s61 offen lds
  s_lshr_b32 s12, s15, 2
  s_lshl_b32 s13, s12, 2
  s_add_u32 s13, s13, s64
  s_sub_u32 s14, s12, s8
  s_add_u32 s14, s14, s9
  s_cmp_lt_u32 s12, s8
  s_cselect_b32 s13, s13, s14
  s_lshl_b32 s13, s13, 14
  s_and_b32 s12, s15, 3
  s_lshl_b32 s12, s12, 12
  s_add_u32 s13, s13, s12
  s_add_u32 s13, s13, s60
  s_cmp_lt_u32 s15, s10
  s_cselect_b32 s75, s13, 0x40000000
  s_add_u32 s15, s15, 4
  buffer_load_dwordx4 v[152:155], v4, s[36:39], s75 offen offset:0 nt
  buffer_load_dwordx4 v[156:159], v4, s[36:39], s75 offen offset:256 nt
  buffer_load_dwordx4 v[160:163], v4, s[36:39], s75 offen offset:512 nt
  buffer_load_dwordx4 v[164:167], v4, s[36:39], s75 offen offset:768 nt
  buffer_load_dwordx4 v[168:171], v4, s[40:43], s75 offen offset:0 nt
  buffer_load_dwordx4 v[172:175], v4, s[40:43], s75 offen offset:256 nt
  buffer_load_dwordx4 v[176:179], v4, s[40:43], s75 offen offset:512 nt
  buffer_load_dwordx4 v[180:183], v4, s[40:43], s75 offen offset:768 nt
  v_mov_b32 v48, 0
  v_mov_b32 v49, 0
  v_mov_b32 v50, 0
  v_mov_b32 v51, 0
  v_mov_b32 v52, 0
  v_mov_b32 v53, 0
  v_mov_b32 v54, 0
  v_mov_b32 v55, 0
  v_lshlrev_b32 v14, 4, v0
  v_add_u32 v14, s70, v14
  s_waitcnt vmcnt(62)
  ds_read_b128 v[200:203], v14 offset:0
  ds_read_b128 v[204:207], v14 offset:1024
  s_waitcnt vmcnt(60)
  ds_read_b128 v[208:211], v14 offset:2048
  ds_read_b128 v[212:215], v14 offset:3072
  s_waitcnt vmcnt(58)
  ds_read_b128 v[216:219], v14 offset:4096
  ds_read_b128 v[220:223], v14 offset:5120
  s_waitcnt lgkmcnt(4)
  v_perm_b32 v10, v204, v200, s65
  v_perm_b32 v11, v204, v200, s66
  v_dot2_f32_bf16 v48, v10, v184, v48
  v_dot2_f32_bf16 v49, v11, v184, v49
  v_perm_b32 v12, v205, v201, s65
  v_perm_b32 v13, v205, v201, s66
  v_dot2_f32_bf16 v50, v12, v184, v50
  v_dot2_f32_bf16 v51, v13, v184, v51
  v_perm_b32 v10, v206, v202, s65
  v_perm_b32 v11, v206, v202, s66
  v_dot2_f32_bf16 v52, v10, v184, v52
  v_dot2_f32_bf16 v53, v11, v184, v53
  v_perm_b32 v12, v207, v203, s65
  v_perm_b32 v13, v207, v203, s66
  v_dot2_f32_bf16 v54, v12, v184, v54
  v_dot2_f32_bf16 v55, v13, v184, v55
  s_waitcnt vmcnt(56)
  ds_read_b128 v[224:227], v14 offset:6144
  ds_read_b128 v[228:231], v14 offset:7168
  s_waitcnt lgkmcnt(4)
  v_perm_b32 v10, v212, v208, s65
  v_perm_b32 v11, v212, v208, s66
  v_dot2_f32_bf16 v48, v10, v185, v48
  v_dot2_f32_bf16 v49, v11, v185, v49
  v_perm_b32 v12, v213, v209, s65
  v_perm_b32 v13, v213, v209, s66
  v_dot2_f32_bf16 v50, v12, v185, v50
  v_dot2_f32_bf16 v51, v13, v185, v51
  v_perm_b32 v10, v214, v210, s65
  v_perm_b32 v11, v214, v210, s66
  v_dot2_f32_bf16 v52, v10, v185, v52
  v_dot2_f32_bf16 v53, v11, v185, v53
  v_perm_b32 v12, v215, v211, s65
  v_perm_b32 v13, v215, v211, s66
  v_dot2_f32_bf16 v54, v12, v185, v54
  v_dot2_f32_bf16 v55, v13, v185, v55
  s_waitcnt vmcnt(46)
  ds_read_b128 v[200:203], v14 offset:8192
  ds_read_b128 v[204:207], v14 offset:9216
  s_waitcnt lgkmcnt(4)
  v_perm_b32 v10, v220, v216, s65
  v_perm_b32 v11, v220, v216, s66
  v_dot2_f32_bf16 v48, v10, v186, v48
  v_dot2_f32_bf16 v49, v11, v186, v49
  v_perm_b32 v12, v221, v217, s65
  v_perm_b32 v13, v221, v217, s66
  v_dot2_f32_bf16 v50, v12, v186, v50
  v_dot2_f32_bf16 v51, v13, v186, v51
  v_perm_b32 v10, v222, v218, s65
  v_perm_b32 v11, v222, v218, s66
  v_dot2_f32_bf16 v52, v10, v186, v52
  v_dot2_f32_bf16 v53, v11, v186, v53
  v_perm_b32 v12, v223, v219, s65
  v_perm_b32 v13, v223, v219, s66
  v_dot2_f32_bf16 v54, v12, v186, v54
  v_dot2_f32_bf16 v55, v13, v186, v55
  s_waitcnt vmcnt(44)
  ds_read_b128 v[208:211], v14 offset:10240
  ds_read_b128 v[212:215], v14 offset:11264
  s_waitcnt lgkmcnt(4)
  v_perm_b32 v10, v228, v224, s65
  v_perm_b32 v11, v228, v224, s66
  v_dot2_f32_bf16 v48, v10, v187, v48
  v_dot2_f32_bf16 v49, v11, v187, v49
  v_perm_b32 v12, v229, v225, s65
  v_perm_b32 v13, v229, v225, s66
  v_dot2_f32_bf16 v50, v12, v187, v50
  v_dot2_f32_bf16 v51, v13, v187, v51
  v_perm_b32 v10, v230, v226, s65
  v_perm_b32 v11, v230, v226, s66
  v_dot2_f32_bf16 v52, v10, v187, v52
  v_dot2_f32_bf16 v53, v11, v187, v53
  v_perm_b32 v12, v231, v227, s65
  v_perm_b32 v13, v231, v227, s66
  v_dot2_f32_bf16 v54, v12, v187, v54
  v_dot2_f32_bf16 v55, v13, v187, v55
  s_waitcnt vmcnt(42)
  ds_read_b128 v[216:219], v14 offset:12288
  ds_read_b128 v[220:223], v14 offset:13312
  s_waitcnt lgkmcnt(4)
  v_perm_b32 v10, v204, v200, s65
  v_perm_b32 v11, v204, v200, s66
  v_dot2_f32_bf16 v48, v10, v188, v48
  v_dot2_f32_bf16 v49, v11, v188, v49
  v_perm_b32 v12, v205, v201, s65
  v_perm_b32 v13, v205, v201, s66
  v_dot2_f32_bf16 v50, v12, v188, v50
  v_dot2_f32_bf16 v51, v13, v188, v51
  v_perm_b32 v10, v206, v202, s65
  v_perm_b32 v11, v206, v202, s66
  v_dot2_f32_bf16 v52, v10, v188, v52
  v_dot2_f32_bf16 v53, v11, v188, v53
  v_perm_b32 v12, v207, v203, s65
  v_perm_b32 v13, v207, v203, s66
  v_dot2_f32_bf16 v54, v12, v188, v54
  v_dot2_f32_bf16 v55, v13, v188, v55
  s_waitcnt vmcnt(40)
  ds_read_b128 v[224:227], v14 offset:14336
  ds_read_b128 v[228:231], v14 offset:15360
  s_waitcnt lgkmcnt(4)
  v_perm_b32 v10, v212, v208, s65
  v_perm_b32 v11, v212, v208, s66
  v_dot2_f32_bf16 v48, v10, v189, v48
  v_dot2_f32_bf16 v49, v11, v189, v49
  v_perm_b32 v12, v213, v209, s65
  v_perm_b32 v13, v213, v209, s66
  v_dot2_f32_bf16 v50, v12, v189, v50
  v_dot2_f32_bf16 v51, v13, v189, v51
  v_perm_b32 v10, v214, v210, s65
  v_perm_b32 v11, v214, v210, s66
  v_dot2_f32_bf16 v52, v10, v189, v52
  v_dot2_f32_bf16 v53, v11, v189, v53
  v_perm_b32 v12, v215, v211, s65
  v_perm_b32 v13, v215, v211, s66
  v_dot2_f32_bf16 v54, v12, v189, v54
  v_dot2_f32_bf16 v55, v13, v189, v55
  s_waitcnt vmcnt(30)
  ds_read_b128 v[200:203], v14 offset:16384
  ds_read_b128 v[204:207], v14 offset:17408
  s_waitcnt lgkmcnt(4)
  v_perm_b32 v10, v220, v216, s65
  v_perm_b32 v11, v220, v216, s66
  v_dot2_f32_bf16 v48, v10, v190, v48
  v_dot2_f32_bf16 v49, v11, v190, v49
  v_perm_b32 v12, v221, v217, s65
  v_perm_b32 v13, v221, v217, s66
  v_dot2_f32_bf16 v50, v12, v190, v50
  v_dot2_f32_bf16 v51, v13, v190, v51
  v_perm_b32 v10, v222, v218, s65
  v_perm_b32 v11, v222, v218, s66
  v_dot2_f32_bf16 v52, v10, v190, v52
  v_dot2_f32_bf16 v53, v11, v190, v53
  v_perm_b32 v12, v223, v219, s65
  v_perm_b32 v13, v223, v219, s66
  v_dot2_f32_bf16 v54, v12, v190, v54
  v_dot2_f32_bf16 v55, v13, v190, v55
  s_waitcnt vmcnt(28)
  ds_read_b128 v[208:211], v14 offset:18432
  ds_read_b128 v[212:215], v14 offset:19456
  s_waitcnt lgkmcnt(4)
  v_perm_b32 v10, v228, v224, s65
  v_perm_b32 v11, v228, v224, s66
  v_dot2_f32_bf16 v48, v10, v191, v48
  v_dot2_f32_bf16 v49, v11, v191, v49
  v_perm_b32 v12, v229, v225, s65
  v_perm_b32 v13, v229, v225, s66
  v_dot2_f32_bf16 v50, v12, v191, v50
  v_dot2_f32_bf16 v51, v13, v191, v51
  v_perm_b32 v10, v230, v226, s65
  v_perm_b32 v11, v230, v226, s66
  v_dot2_f32_bf16 v52, v10, v191, v52
  v_dot2_f32_bf16 v53, v11, v191, v53
  v_perm_b32 v12, v231, v227, s65
  v_perm_b32 v13, v231, v227, s66
  v_dot2_f32_bf16 v54, v12, v191, v54
  v_dot2_f32_bf16 v55, v13, v191, v55
  s_waitcnt vmcnt(26)
  ds_read_b128 v[216:219], v14 offset:20480
  ds_read_b128 v[220:223], v14 offset:21504
  s_waitcnt lgkmcnt(4)
  v_perm_b32 v10, v204, v200, s65
  v_perm_b32 v11, v204, v200, s66
  v_dot2_f32_bf16 v48, v10, v192, v48
  v_dot2_f32_bf16 v49, v11, v192, v49
  v_perm_b32 v12, v205, v201, s65
  v_perm_b32 v13, v205, v201, s66
  v_dot2_f32_bf16 v50, v12, v192, v50
  v_dot2_f32_bf16 v51, v13, v192, v51
  v_perm_b32 v10, v206, v202, s65
  v_perm_b32 v11, v206, v202, s66
  v_dot2_f32_bf16 v52, v10, v192, v52
  v_dot2_f32_bf16 v53, v11, v192, v53
  v_perm_b32 v12, v207, v203, s65
  v_perm_b32 v13, v207, v203, s66
  v_dot2_f32_bf16 v54, v12, v192, v54
  v_dot2_f32_bf16 v55, v13, v192, v55
  s_waitcnt vmcnt(24)
  ds_read_b128 v[224:227], v14 offset:22528
  ds_read_b128 v[228:231], v14 offset:23552
  s_waitcnt lgkmcnt(4)
  v_perm_b32 v10, v212, v208, s65
  v_perm_b32 v11, v212, v208, s66
  v_dot2_f32_bf16 v48, v10, v193, v48
  v_dot2_f32_bf16 v49, v11, v193, v49
  v_perm_b32 v12, v213, v209, s65
  v_perm_b32 v13, v213, v209, s66
  v_dot2_f32_bf16 v50, v12, v193, v50
  v_dot2_f32_bf16 v51, v13, v193, v51
  v_perm_b32 v10, v214, v210, s65
  v_perm_b32 v11, v214, v210, s66
  v_dot2_f32_bf16 v52, v10, v193, v52
  v_dot2_f32_bf16 v53, v11, v193, v53
  v_perm_b32 v12, v215, v211, s65
  v_perm_b32 v13, v215, v211, s66
  v_dot2_f32_bf16 v54, v12, v193, v54
  v_dot2_f32_bf16 v55, v13, v193, v55
  s_waitcnt vmcnt(14)
  ds_read_b128 v[200:203], v14 offset:24576
  ds_read_b128 v[204:207], v14 offset:25600
  s_waitcnt lgkmcnt(4)
  v_perm_b32 v10, v220, v216, s65
  v_perm_b32 v11, v220, v216, s66
  v_dot2_f32_bf16 v48, v10, v194, v48
  v_dot2_f32_bf16 v49, v11, v194, v49
  v_perm_b32 v12, v221, v217, s65
  v_perm_b32 v13, v221, v217, s66
  v_dot2_f32_bf16 v50, v12, v194, v50
  v_dot2_f32_bf16 v51, v13, v194, v51
  v_perm_b32 v10, v222, v218, s65
  v_perm_b32 v11, v222, v218, s66
  v_dot2_f32_bf16 v52, v10, v194, v52
  v_dot2_f32_bf16 v53, v11, v194, v53
  v_perm_b32 v12, v223, v219, s65
  v_perm_b32 v13, v223, v219, s66
  v_dot2_f32_bf16 v54, v12, v194, v54
  v_dot2_f32_bf16 v55, v13, v194, v55
  s_waitcnt vmcnt(12)
  ds_read_b128 v[208:211], v14 offset:26624
  ds_read_b128 v[212:215], v14 offset:27648
  s_waitcnt lgkmcnt(4)
  v_perm_b32 v10, v228, v224, s65
  v_perm_b32 v11, v228, v224, s66
  v_dot2_f32_bf16 v48, v10, v195, v48
  v_dot2_f32_bf16 v49, v11, v195, v49
  v_perm_b32 v12, v229, v225, s65
  v_perm_b32 v13, v229, v225, s66
  v_dot2_f32_bf16 v50, v12, v195, v50
  v_dot2_f32_bf16 v51, v13, v195, v51
  v_perm_b32 v10, v230, v226, s65
  v_perm_b32 v11, v230, v226, s66
  v_dot2_f32_bf16 v52, v10, v195, v52
  v_dot2_f32_bf16 v53, v11, v195, v53
  v_perm_b32 v12, v231, v227, s65
  v_perm_b32 v13, v231, v227, s66
  v_dot2_f32_bf16 v54, v12, v195, v54
  v_dot2_f32_bf16 v55, v13, v195, v55
  s_waitcnt vmcnt(10)
  ds_read_b128 v[216:219], v14 offset:28672
  ds_read_b128 v[220:223], v14 offset:29696
  s_waitcnt lgkmcnt(4)
  v_perm_b32 v10, v204, v200, s65
  v_perm_b32 v11, v204, v200, s66
  v_dot2_f32_bf16 v48, v10, v196, v48
  v_dot2_f32_bf16 v49, v11, v196, v49
  v_perm_b32 v12, v205, v201, s65
  v_perm_b32 v13, v205, v201, s66
  v_dot2_f32_bf16 v50, v12, v196, v50
  v_dot2_f32_bf16 v51, v13, v196, v51
  v_perm_b32 v10, v206, v202, s65
  v_perm_b32 v11, v206, v202, s66
  v_dot2_f32_bf16 v52, v10, v196, v52
  v_dot2_f32_bf16 v53, v11, v196, v53
  v_perm_b32 v12, v207, v203, s65
  v_perm_b32 v13, v207, v203, s66
  v_dot2_f32_bf16 v54, v12, v196, v54
  v_dot2_f32_bf16 v55, v13, v196, v55
  s_waitcnt vmcnt(8)
  ds_read_b128 v[224:227], v14 offset:30720
  ds_read_b128 v[228:231], v14 offset:31744
  s_waitcnt lgkmcnt(4)
  v_perm_b32 v10, v212, v208, s65
  v_perm_b32 v11, v212, v208, s66
  v_dot2_f32_bf16 v48, v10, v197, v48
  v_dot2_f32_bf16 v49, v11, v197, v49
  v_perm_b32 v12, v213, v209, s65
  v_perm_b32 v13, v213, v209, s66
  v_dot2_f32_bf16 v50, v12, v197, v50
  v_dot2_f32_bf16 v51, v13, v197, v51
  v_perm_b32 v10, v214, v210, s65
  v_perm_b32 v11, v214, v210, s66
  v_dot2_f32_bf16 v52, v10, v197, v52
  v_dot2_f32_bf16 v53, v11, v197, v53
  v_perm_b32 v12, v215, v211, s65
  v_perm_b32 v13, v215, v211, s66
  v_dot2_f32_bf16 v54, v12, v197, v54
  v_dot2_f32_bf16 v55, v13, v197, v55
  s_waitcnt lgkmcnt(2)
  v_perm_b32 v10, v220, v216, s65
  v_perm_b32 v11, v220, v216, s66
  v_dot2_f32_bf16 v48, v10, v198, v48
  v_dot2_f32_bf16 v49, v11, v198, v49
  v_perm_b32 v12, v221, v217, s65
  v_perm_b32 v13, v221, v217, s66
  v_dot2_f32_bf16 v50, v12, v198, v50
  v_dot2_f32_bf16 v51, v13, v198, v51
  v_perm_b32 v10, v222, v218, s65
  v_perm_b32 v11, v222, v218, s66
  v_dot2_f32_bf16 v52, v10, v198, v52
  v_dot2_f32_bf16 v53, v11, v198, v53
  v_perm_b32 v12, v223, v219, s65
  v_perm_b32 v13, v223, v219, s66
  v_dot2_f32_bf16 v54, v12, v198, v54
  v_dot2_f32_bf16 v55, v13, v198, v55
  s_waitcnt lgkmcnt(0)
  v_perm_b32 v10, v228, v224, s65
  v_perm_b32 v11, v228, v224, s66
  v_dot2_f32_bf16 v48, v10, v199, v48
  v_dot2_f32_bf16 v49, v11, v199, v49
  v_perm_b32 v12, v229, v225, s65
  v_perm_b32 v13, v229, v225, s66
  v_dot2_f32_bf16 v50, v12, v199, v50
  v_dot2_f32_bf16 v51, v13, v199, v51
  v_perm_b32 v10, v230, v226, s65
  v_perm_b32 v11, v230, v226, s66
  v_dot2_f32_bf16 v52, v10, v199, v52
  v_dot2_f32_bf16 v53, v11, v199, v53
  v_perm_b32 v12, v231, v227, s65
  v_perm_b32 v13, v231, v227, s66
  v_dot2_f32_bf16 v54, v12, v199, v54
  v_dot2_f32_bf16 v55, v13, v199, v55
  s_nop 2
  v_permlane32_swap_b32 v48, v52
  v_permlane32_swap_b32 v49, v53
  v_permlane32_swap_b32 v50, v54
  v_permlane32_swap_b32 v51, v55
  v_add_f32 v48, v48, v52
  v_add_f32 v49, v49, v53
  v_add_f32 v50, v50, v54
  v_add_f32 v51, v51, v55
  s_nop 1
  v_permlane16_swap_b32 v48, v50
  v_permlane16_swap_b32 v49, v51
  v_add_f32 v48, v48, v50
  v_add_f32 v49, v49, v51
  ds_write_b64 v7, v[48:49] offset:0
  s_waitcnt lgkmcnt(0)
  s_mov_b64 exec, 1
  ds_add_u32 v249, v250 offset:8332
  s_mov_b64 exec, -1
L1_poll2:
  ds_read_b32 v8, v249 offset:8332
  s_waitcnt lgkmcnt(0)
  v_readfirstlane_b32 s61, v8
  s_cmp_ge_u32 s61, 4
  s_cbranch_scc1 L1_polled2
  s_sleep 1
  s_branch L1_poll2
L1_polled2:
  v_lshlrev_b32 v8, 3, v0
  ds_read_b64 v[24:25], v8 offset:0
  ds_read_b64 v[26:27], v8 offset:512
  ds_read_b64 v[28:29], v8 offset:1024
  ds_read_b64 v[30:31], v8 offset:1536
  s_lshl_b32 s61, s3, 8
  v_lshlrev_b32 v9, 2, v0
  v_add_u32 v9, s61, v9
  v_lshlrev_b32 v10, 4, v2
  v_add_u32 v10, s61, v10
  v_lshlrev_b32 v12, 4, v1
  v_add_u32 v12, s61, v12
  s_waitcnt lgkmcnt(0)
  v_add_f32 v24, v24, v26
  v_add_f32 v25, v25, v27
  v_add_f32 v28, v28, v30
  v_add_f32 v29, v29, v31
  v_add_f32 v24, v24, v28
  v_add_f32 v25, v25, v29
  v_cvt_pk_bf16_f32 v11, v24, v25
  ds_write_b32 v9, v11 offset:2048
  s_waitcnt lgkmcnt(0)
  ds_read_b128 v[52:55], v10 offset:2048
  ds_read_b128 v[24:27], v12 offset:2048
  ds_read_b128 v[28:31], v12 offset:2112
  ds_read_b128 v[32:35], v12 offset:2176
  ds_read_b128 v[36:39], v12 offset:2240
  v_mov_b32 v5, 0xff61b1e6
  v_mov_b32 v6, 0
  v_mov_b32 v40, 0
  v_mov_b32 v41, 0
  v_mov_b32 v42, 0
  v_mov_b32 v43, 0
  v_mov_b32 v44, 0
  v_mov_b32 v45, 0
  v_mov_b32 v46, 0
  v_mov_b32 v47, 0
  s_waitcnt lgkmcnt(0)
  s_setprio 0
  s_mov_b64 exec, 1
  ds_add_rtn_u32 v23, v249, v250 offset:8328
  s_mov_b64 exec, -1
  v_lshrrev_b32 v251, 3, v0
  v_lshlrev_b32 v251, 10, v251
  v_and_b32 v20, 7, v0
  v_lshl_add_u32 v251, v20, 4, v251
  s_lshl_b32 s83, s62, 17
  s_lshl_b32 s61, s3, 7
  s_add_u32 s83, s83, s61
  v_dot2_f32_bf16 v48, v56, v52, 0
  v_dot2_f32_bf16 v49, v60, v52, 0
  v_dot2_f32_bf16 v50, v64, v52, 0
  v_dot2_f32_bf16 v51, v68, v52, 0
  v_dot2_f32_bf16 v48, v57, v53, v48
  v_dot2_f32_bf16 v49, v61, v53, v49
  v_dot2_f32_bf16 v50, v65, v53, v50
  v_dot2_f32_bf16 v51, v69, v53, v51
  v_dot2_f32_bf16 v48, v58, v54, v48
  v_dot2_f32_bf16 v49, v62, v54, v49
  v_dot2_f32_bf16 v50, v66, v54, v50
  v_dot2_f32_bf16 v51, v70, v54, v51
  v_dot2_f32_bf16 v48, v59, v55, v48
  v_dot2_f32_bf16 v49, v63, v55, v49
  v_dot2_f32_bf16 v50, v67, v55, v50
  v_dot2_f32_bf16 v51, v71, v55, v51
  s_nop 0
  v_add_f32_dpp v48, v48, v48 row_ror:8 row_mask:0xf bank_mask:0xf
  v_add_f32_dpp v49, v49, v49 row_ror:8 row_mask:0xf bank_mask:0xf
  v_add_f32_dpp v50, v50, v50 row_ror:8 row_mask:0xf bank_mask:0xf
  v_add_f32_dpp v51, v51, v51 row_ror:8 row_mask:0xf bank_mask:0xf
  v_add_f32_dpp v48, v48, v48 row_ror:4 row_mask:0xf bank_mask:0xf
  v_add_f32_dpp v49, v49, v49 row_ror:4 row_mask:0xf bank_mask:0xf
  v_add_f32_dpp v50, v50, v50 row_ror:4 row_mask:0xf bank_mask:0xf
  v_add_f32_dpp v51, v51, v51 row_ror:4 row_mask:0xf bank_mask:0xf
  v_add_f32_dpp v48, v48, v48 row_ror:2 row_mask:0xf bank_mask:0xf
  v_add_f32_dpp v49, v49, v49 row_ror:2 row_mask:0xf bank_mask:0xf
  v_add_f32_dpp v50, v50, v50 row_ror:2 row_mask:0xf bank_mask:0xf
  v_add_f32_dpp v51, v51, v51 row_ror:2 row_mask:0xf bank_mask:0xf
  v_add_f32_dpp v48, v48, v48 row_ror:1 row_mask:0xf bank_mask:0xf
  v_add_f32_dpp v49, v49, v49 row_ror:1 row_mask:0xf bank_mask:0xf
  v_add_f32_dpp v50, v50, v50 row_ror:1 row_mask:0xf bank_mask:0xf
  v_add_f32_dpp v51, v51, v51 row_ror:1 row_mask:0xf bank_mask:0xf
  v_cvt_pk_bf16_f32 v16, v48, v49
  v_lshlrev_b32 v48, 16, v16
  v_and_b32 v49, 0xffff0000, v16
  v_mul_f32 v48, s68, v48
  v_mul_f32 v49, s68, v49
  v_cvt_pk_bf16_f32 v16, v48, v49
  v_lshlrev_b32 v48, 16, v16
  v_and_b32 v49, 0xffff0000, v16
  v_cvt_pk_bf16_f32 v16, v50, v51
  v_lshlrev_b32 v50, 16, v16
  v_and_b32 v51, 0xffff0000, v16
  v_mul_f32 v50, s68, v50
  v_mul_f32 v51, s68, v51
  v_cvt_pk_bf16_f32 v16, v50, v51
  v_lshlrev_b32 v50, 16, v16
  v_and_b32 v51, 0xffff0000, v16
  v_max3_f32 v8, v48, v49, v5
  v_max3_f32 v8, v50, v51, v8
  v_sub_f32 v9, v5, v8
  v_mul_f32 v10, s67, v8
  v_mul_f32 v9, s67, v9
  v_fma_f32 v12, v48, s67, -v10
  v_fma_f32 v13, v49, s67, -v10
  v_fma_f32 v14, v50, s67, -v10
  v_fma_f32 v15, v51, s67, -v10
  v_exp_f32 v9, v9
  v_exp_f32 v12, v12
  v_exp_f32 v13, v13
  v_exp_f32 v14, v14
  v_exp_f32 v15, v15
  v_mov_b32 v5, v8
  v_mul_f32 v40, v9, v40
  v_mul_f32 v41, v9, v41
  v_mul_f32 v42, v9, v42
  v_mul_f32 v43, v9, v43
  v_mul_f32 v44, v9, v44
  v_mul_f32 v45, v9, v45
  v_mul_f32 v46, v9, v46
  v_mul_f32 v47, v9, v47
  v_cvt_pk_bf16_f32 v18, v12, v13
  v_cvt_pk_bf16_f32 v19, v14, v15
  v_add_f32 v16, v12, v13
  v_add_f32 v17, v14, v15
  v_add_f32 v16, v16, v17
  v_fma_f32 v6, v6, v9, v16
  v_perm_b32 v20, v76, v72, s65
  v_perm_b32 v21, v76, v72, s66
  v_dot2_f32_bf16 v40, v20, v18, v40
  v_dot2_f32_bf16 v41, v21, v18, v41
  v_perm_b32 v22, v77, v73, s65
  v_perm_b32 v11, v77, v73, s66
  v_dot2_f32_bf16 v42, v22, v18, v42
  v_dot2_f32_bf16 v43, v11, v18, v43
  v_perm_b32 v20, v78, v74, s65
  v_perm_b32 v21, v78, v74, s66
  v_dot2_f32_bf16 v44, v20, v18, v44
  v_dot2_f32_bf16 v45, v21, v18, v45
  v_perm_b32 v22, v79, v75, s65
  v_perm_b32 v11, v79, v75, s66
  v_dot2_f32_bf16 v46, v22, v18, v46
  v_dot2_f32_bf16 v47, v11, v18, v47
  v_perm_b32 v20, v84, v80, s65
  v_perm_b32 v21, v84, v80, s66
  v_dot2_f32_bf16 v40, v20, v19, v40
  v_dot2_f32_bf16 v41, v21, v19, v41
  v_perm_b32 v22, v85, v81, s65
  v_perm_b32 v11, v85, v81, s66
  v_dot2_f32_bf16 v42, v22, v19, v42
  v_dot2_f32_bf16 v43, v11, v19, v43
  v_perm_b32 v20, v86, v82, s65
  v_perm_b32 v21, v86, v82, s66
  v_dot2_f32_bf16 v44, v20, v19, v44
  v_dot2_f32_bf16 v45, v21, v19, v45
  v_perm_b32 v22, v87, v83, s65
  v_perm_b32 v11, v87, v83, s66
  v_dot2_f32_bf16 v46, v22, v19, v46
  v_dot2_f32_bf16 v47, v11, v19, v47
  s_cmp_eq_u32 s73, 0x40000000
  s_cbranch_scc1 L1_exit
  s_waitcnt lgkmcnt(0)
  v_readfirstlane_b32 s61, v23
  s_lshr_b32 s12, s61, 2
  s_lshl_b32 s13, s12, 2
  s_add_u32 s13, s13, s64
  s_sub_u32 s14, s12, s8
  s_add_u32 s14, s14, s9
  s_cmp_lt_u32 s12, s8
  s_cselect_b32 s13, s13, s14
  s_lshl_b32 s13, s13, 14
  s_and_b32 s12, s61, 3
  s_lshl_b32 s12, s12, 12
  s_add_u32 s13, s13, s12
  s_add_u32 s13, s13, s60
  s_cmp_lt_u32 s61, s10
  s_cselect_b32 s72, s13, 0x40000000
  s_mov_b64 exec, 1
  ds_add_rtn_u32 v23, v249, v250 offset:8328
  s_mov_b64 exec, -1
  buffer_load_dwordx4 v[56:59], v3, s[36:39], s72 offen offset:0 nt
  buffer_load_dwordx4 v[60:63], v3, s[36:39], s72 offen offset:64 nt
  buffer_load_dwordx4 v[64:67], v3, s[36:39], s72 offen offset:128 nt
  buffer_load_dwordx4 v[68:71], v3, s[36:39], s72 offen offset:192 nt
  buffer_load_dwordx4 v[72:75], v4, s[40:43], s72 offen offset:0 nt
  buffer_load_dwordx4 v[76:79], v4, s[40:43], s72 offen offset:256 nt
  buffer_load_dwordx4 v[80:83], v4, s[40:43], s72 offen offset:512 nt
  buffer_load_dwordx4 v[84:87], v4, s[40:43], s72 offen offset:768 nt
  s_add_u32 m0, s71, 0
  s_add_u32 s61, s83, 0
  buffer_load_dwordx4 v251, s[44:47], s61 offen lds
  s_add_u32 m0, s71, 1024
  s_add_u32 s61, s83, 8192
  buffer_load_dwordx4 v251, s[44:47], s61 offen lds
  v_dot2_f32_bf16 v48, v88, v52, 0
  v_dot2_f32_bf16 v49, v92, v52, 0
  v_dot2_f32_bf16 v50, v96, v52, 0
  v_dot2_f32_bf16 v51, v100, v52, 0
  v_dot2_f32_bf16 v48, v89, v53, v48
  v_dot2_f32_bf16 v49, v93, v53, v49
  v_dot2_f32_bf16 v50, v97, v53, v50
  v_dot2_f32_bf16 v51, v101, v53, v51
  v_dot2_f32_bf16 v48, v90, v54, v48
  v_dot2_f32_bf16 v49, v94, v54, v49
  v_dot2_f32_bf16 v50, v98, v54, v50
  v_dot2_f32_bf16 v51, v102, v54, v51
  v_dot2_f32_bf16 v48, v91, v55, v48
  v_dot2_f32_bf16 v49, v95, v55, v49
  v_dot2_f32_bf16 v50, v99, v55, v50
  v_dot2_f32_bf16 v51, v103, v55, v51
  s_nop 0
  v_add_f32_dpp v48, v48, v48 row_ror:8 row_mask:0xf bank_mask:0xf
  v_add_f32_dpp v49, v49, v49 row_ror:8 row_mask:0xf bank_mask:0xf
  v_add_f32_dpp v50, v50, v50 row_ror:8 row_mask:0xf bank_mask:0xf
  v_add_f32_dpp v51, v51, v51 row_ror:8 row_mask:0xf bank_mask:0xf
  v_add_f32_dpp v48, v48, v48 row_ror:4 row_mask:0xf bank_mask:0xf
  v_add_f32_dpp v49, v49, v49 row_ror:4 row_mask:0xf bank_mask:0xf
  v_add_f32_dpp v50, v50, v50 row_ror:4 row_mask:0xf bank_mask:0xf
  v_add_f32_dpp v51, v51, v51 row_ror:4 row_mask:0xf bank_mask:0xf
  v_add_f32_dpp v48, v48, v48 row_ror:2 row_mask:0xf bank_mask:0xf
  v_add_f32_dpp v49, v49, v49 row_ror:2 row_mask:0xf bank_mask:0xf
  v_add_f32_dpp v50, v50, v50 row_ror:2 row_mask:0xf bank_mask:0xf
  v_add_f32_dpp v51, v51, v51 row_ror:2 row_mask:0xf bank_mask:0xf
  v_add_f32_dpp v48, v48, v48 row_ror:1 row_mask:0xf bank_mask:0xf
  v_add_f32_dpp v49, v49, v49 row_ror:1 row_mask:0xf bank_mask:0xf
  v_add_f32_dpp v50, v50, v50 row_ror:1 row_mask:0xf bank_mask:0xf
  v_add_f32_dpp v51, v51, v51 row_ror:1 row_mask:0xf bank_mask:0xf
  v_cvt_pk_bf16_f32 v16, v48, v49
  v_lshlrev_b32 v48, 16, v16
  v_and_b32 v49, 0xffff0000, v16
  v_mul_f32 v48, s68, v48
  v_mul_f32 v49, s68, v49
  v_cvt_pk_bf16_f32 v16, v48, v49
  v_lshlrev_b32 v48, 16, v16
  v_and_b32 v49, 0xffff0000, v16
  v_cvt_pk_bf16_f32 v16, v50, v51
  v_lshlrev_b32 v50, 16, v16
  v_and_b32 v51, 0xffff0000, v16
  v_mul_f32 v50, s68, v50
  v_mul_f32 v51, s68, v51
  v_cvt_pk_bf16_f32 v16, v50, v51
  v_lshlrev_b32 v50, 16, v16
  v_and_b32 v51, 0xffff0000, v16
  v_max3_f32 v8, v48, v49, v5
  v_max3_f32 v8, v50, v51, v8
  v_sub_f32 v9, v5, v8
  v_mul_f32 v10, s67, v8
  v_mul_f32 v9, s67, v9
  v_fma_f32 v12, v48, s67, -v10
  v_fma_f32 v13, v49, s67, -v10
  v_fma_f32 v14, v50, s67, -v10
  v_fma_f32 v15, v51, s67, -v10
  v_exp_f32 v9, v9
  v_exp_f32 v12, v12
  v_exp_f32 v13, v13
  v_exp_f32 v14, v14
  v_exp_f32 v15, v15
  v_mov_b32 v5, v8
  v_mul_f32 v40, v9, v40
  v_mul_f32 v41, v9, v41
  v_mul_f32 v42, v9, v42
  v_mul_f32 v43, v9, v43
  v_mul_f32 v44, v9, v44
  v_mul_f32 v45, v9, v45
  v_mul_f32 v46, v9, v46
  v_mul_f32 v47, v9, v47
  v_cvt_pk_bf16_f32 v18, v12, v13
  v_cvt_pk_bf16_f32 v19, v14, v15
  v_add_f32 v16, v12, v13
  v_add_f32 v17, v14, v15
  v_add_f32 v16, v16, v17
  v_fma_f32 v6, v6, v9, v16
  v_perm_b32 v20, v108, v104, s65
  v_perm_b32 v21, v108, v104, s66
  v_dot2_f32_bf16 v40, v20, v18, v40
  v_dot2_f32_bf16 v41, v21, v18, v41
  v_perm_b32 v22, v109, v105, s65
  v_perm_b32 v11, v109, v105, s66
  v_dot2_f32_bf16 v42, v22, v18, v42
  v_dot2_f32_bf16 v43, v11, v18, v43
  v_perm_b32 v20, v110, v106, s65
  v_perm_b32 v21, v110, v106, s66
  v_dot2_f32_bf16 v44, v20, v18, v44
  v_dot2_f32_bf16 v45, v21, v18, v45
  v_perm_b32 v22, v111, v107, s65
  v_perm_b32 v11, v111, v107, s66
  v_dot2_f32_bf16 v46, v22, v18, v46
  v_dot2_f32_bf16 v47, v11, v18, v47
  v_perm_b32 v20, v116, v112, s65
  v_perm_b32 v21, v116, v112, s66
  v_dot2_f32_bf16 v40, v20, v19, v40
  v_dot2_f32_bf16 v41, v21, v19, v41
  v_perm_b32 v22, v117, v113, s65
  v_perm_b32 v11, v117, v113, s66
  v_dot2_f32_bf16 v42, v22, v19, v42
  v_dot2_f32_bf16 v43, v11, v19, v43
  v_perm_b32 v20, v118, v114, s65
  v_perm_b32 v21, v118, v114, s66
  v_dot2_f32_bf16 v44, v20, v19, v44
  v_dot2_f32_bf16 v45, v21, v19, v45
  v_perm_b32 v22, v119, v115, s65
  v_perm_b32 v11, v119, v115, s66
  v_dot2_f32_bf16 v46, v22, v19, v46
  v_dot2_f32_bf16 v47, v11, v19, v47
  s_cmp_eq_u32 s74, 0x40000000
  s_cbranch_scc1 L1_exit
  s_waitcnt lgkmcnt(0)
  v_readfirstlane_b32 s61, v23
  s_lshr_b32 s12, s61, 2
  s_lshl_b32 s13, s12, 2
  s_add_u32 s13, s13, s64
  s_sub_u32 s14, s12, s8
  s_add_u32 s14, s14, s9
  s_cmp_lt_u32 s12, s8
  s_cselect_b32 s13, s13, s14
  s_lshl_b32 s13, s13, 14
  s_and_b32 s12, s61, 3
  s_lshl_b32 s12, s12, 12
  s_add_u32 s13, s13, s12
  s_add_u32 s13, s13, s60
  s_cmp_lt_u32 s61, s10
  s_cselect_b32 s73, s13, 0x40000000
  s_mov_b64 exec, 1
  ds_add_rtn_u32 v23, v249, v250 offset:8328
  s_mov_b64 exec, -1
  buffer_load_dwordx4 v[88:91], v4, s[36:39], s73 offen offset:0 nt
  buffer_load_dwordx4 v[92:95], v4, s[36:39], s73 offen offset:256 nt
  buffer_load_dwordx4 v[96:99], v4, s[36:39], s73 offen offset:512 nt
  buffer_load_dwordx4 v[100:103], v4, s[36:39], s73 offen offset:768 nt
  buffer_load_dwordx4 v[104:107], v4, s[40:43], s73 offen offset:0 nt
  buffer_load_dwordx4 v[108:111], v4, s[40:43], s73 offen offset:256 nt
  buffer_load_dwordx4 v[112:115], v4, s[40:43], s73 offen offset:512 nt
  buffer_load_dwordx4 v[116:119], v4, s[40:43], s73 offen offset:768 nt
  s_add_u32 m0, s71, 2048
  s_add_u32 s61, s83, 16384
  buffer_load_dwordx4 v251, s[44:47], s61 offen lds
  s_add_u32 m0, s71, 3072
  s_add_u32 s61, s83, 24576
  buffer_load_dwordx4 v251, s[44:47], s61 offen lds
  v_dot2_f32_bf16 v48, v120, v52, 0
  v_dot2_f32_bf16 v49, v124, v52, 0
  v_dot2_f32_bf16 v50, v128, v52, 0
  v_dot2_f32_bf16 v51, v132, v52, 0
  v_dot2_f32_bf16 v48, v121, v53, v48
  v_dot2_f32_bf16 v49, v125, v53, v49
  v_dot2_f32_bf16 v50, v129, v53, v50
  v_dot2_f32_bf16 v51, v133, v53, v51
  v_dot2_f32_bf16 v48, v122, v54, v48
  v_dot2_f32_bf16 v49, v126, v54, v49
  v_dot2_f32_bf16 v50, v130, v54, v50
  v_dot2_f32_bf16 v51, v134, v54, v51
  v_dot2_f32_bf16 v48, v123, v55, v48
  v_dot2_f32_bf16 v49, v127, v55, v49
  v_dot2_f32_bf16 v50, v131, v55, v50
  v_dot2_f32_bf16 v51, v135, v55, v51
  s_nop 0
  v_add_f32_dpp v48, v48, v48 row_ror:8 row_mask:0xf bank_mask:0xf
  v_add_f32_dpp v49, v49, v49 row_ror:8 row_mask:0xf bank_mask:0xf
  v_add_f32_dpp v50, v50, v50 row_ror:8 row_mask:0xf bank_mask:0xf
  v_add_f32_dpp v51, v51, v51 row_ror:8 row_mask:0xf bank_mask:0xf
  v_add_f32_dpp v48, v48, v48 row_ror:4 row_mask:0xf bank_mask:0xf
  v_add_f32_dpp v49, v49, v49 row_ror:4 row_mask:0xf bank_mask:0xf
  v_add_f32_dpp v50, v50, v50 row_ror:4 row_mask:0xf bank_mask:0xf
  v_add_f32_dpp v51, v51, v51 row_ror:4 row_mask:0xf bank_mask:0xf
  v_add_f32_dpp v48, v48, v48 row_ror:2 row_mask:0xf bank_mask:0xf
  v_add_f32_dpp v49, v49, v49 row_ror:2 row_mask:0xf bank_mask:0xf
  v_add_f32_dpp v50, v50, v50 row_ror:2 row_mask:0xf bank_mask:0xf
  v_add_f32_dpp v51, v51, v51 row_ror:2 row_mask:0xf bank_mask:0xf
  v_add_f32_dpp v48, v48, v48 row_ror:1 row_mask:0xf bank_mask:0xf
  v_add_f32_dpp v49, v49, v49 row_ror:1 row_mask:0xf bank_mask:0xf
  v_add_f32_dpp v50, v50, v50 row_ror:1 row_mask:0xf bank_mask:0xf
  v_add_f32_dpp v51, v51, v51 row_ror:1 row_mask:0xf bank_mask:0xf
  v_cvt_pk_bf16_f32 v16, v48, v49
  v_lshlrev_b32 v48, 16, v16
  v_and_b32 v49, 0xffff0000, v16
  v_mul_f32 v48, s68, v48
  v_mul_f32 v49, s68, v49
  v_cvt_pk_bf16_f32 v16, v48, v49
  v_lshlrev_b32 v48, 16, v16
  v_and_b32 v49, 0xffff0000, v16
  v_cvt_pk_bf16_f32 v16, v50, v51
  v_lshlrev_b32 v50, 16, v16
  v_and_b32 v51, 0xffff0000, v16
  v_mul_f32 v50, s68, v50
  v_mul_f32 v51, s68, v51
  v_cvt_pk_bf16_f32 v16, v50, v51
  v_lshlrev_b32 v50, 16, v16
  v_and_b32 v51, 0xffff0000, v16
  v_max3_f32 v8, v48, v49, v5
  v_max3_f32 v8, v50, v51, v8
  v_sub_f32 v9, v5, v8
  v_mul_f32 v10, s67, v8
  v_mul_f32 v9, s67, v9
  v_fma_f32 v12, v48, s67, -v10
  v_fma_f32 v13, v49, s67, -v10
  v_fma_f32 v14, v50, s67, -v10
  v_fma_f32 v15, v51, s67, -v10
  v_exp_f32 v9, v9
  v_exp_f32 v12, v12
  v_exp_f32 v13, v13
  v_exp_f32 v14, v14
  v_exp_f32 v15, v15
  v_mov_b32 v5, v8
  v_mul_f32 v40, v9, v40
  v_mul_f32 v41, v9, v41
  v_mul_f32 v42, v9, v42
  v_mul_f32 v43, v9, v43
  v_mul_f32 v44, v9, v44
  v_mul_f32 v45, v9, v45
  v_mul_f32 v46, v9, v46
  v_mul_f32 v47, v9, v47
  v_cvt_pk_bf16_f32 v18, v12, v13
  v_cvt_pk_bf16_f32 v19, v14, v15
  v_add_f32 v16, v12, v13
  v_add_f32 v17, v14, v15
  v_add_f32 v16, v16, v17
  v_fma_f32 v6, v6, v9, v16
  v_perm_b32 v20, v140, v136, s65
  v_perm_b32 v21, v140, v136, s66
  v_dot2_f32_bf16 v40, v20, v18, v40
  v_dot2_f32_bf16 v41, v21, v18, v41
  v_perm_b32 v22, v141, v137, s65
  v_perm_b32 v11, v141, v137, s66
  v_dot2_f32_bf16 v42, v22, v18, v42
  v_dot2_f32_bf16 v43, v11, v18, v43
  v_perm_b32 v20, v142, v138, s65
  v_perm_b32 v21, v142, v138, s66
  v_dot2_f32_bf16 v44, v20, v18, v44
  v_dot2_f32_bf16 v45, v21, v18, v45
  v_perm_b32 v22, v143, v139, s65
  v_perm_b32 v11, v143, v139, s66
  v_dot2_f32_bf16 v46, v22, v18, v46
  v_dot2_f32_bf16 v47, v11, v18, v47
  v_perm_b32 v20, v148, v144, s65
  v_perm_b32 v21, v148, v144, s66
  v_dot2_f32_bf16 v40, v20, v19, v40
  v_dot2_f32_bf16 v41, v21, v19, v41
  v_perm_b32 v22, v149, v145, s65
  v_perm_b32 v11, v149, v145, s66
  v_dot2_f32_bf16 v42, v22, v19, v42
  v_dot2_f32_bf16 v43, v11, v19, v43
  v_perm_b32 v20, v150, v146, s65
  v_perm_b32 v21, v150, v146, s66
  v_dot2_f32_bf16 v44, v20, v19, v44
  v_dot2_f32_bf16 v45, v21, v19, v45
  v_perm_b32 v22, v151, v147, s65
  v_perm_b32 v11, v151, v147, s66
  v_dot2_f32_bf16 v46, v22, v19, v46
  v_dot2_f32_bf16 v47, v11, v19, v47
  s_cmp_eq_u32 s75, 0x40000000
  s_cbranch_scc1 L1_exit
  s_waitcnt lgkmcnt(0)
  v_readfirstlane_b32 s61, v23
  s_lshr_b32 s12, s61, 2
  s_lshl_b32 s13, s12, 2
  s_add_u32 s13, s13, s64
  s_sub_u32 s14, s12, s8
  s_add_u32 s14, s14, s9
  s_cmp_lt_u32 s12, s8
  s_cselect_b32 s13, s13, s14
  s_lshl_b32 s13, s13, 14
  s_and_b32 s12, s61, 3
  s_lshl_b32 s12, s12, 12
  s_add_u32 s13, s13, s12
  s_add_u32 s13, s13, s60
  s_cmp_lt_u32 s61, s10
  s_cselect_b32 s74, s13, 0x40000000
  s_mov_b64 exec, 1
  ds_add_rtn_u32 v23, v249, v250 offset:8328
  s_mov_b64 exec, -1
  buffer_load_dwordx4 v[120:123], v3, s[36:39], s74 offen offset:0 nt
  buffer_load_dwordx4 v[124:127], v3, s[36:39], s74 offen offset:64 nt
  buffer_load_dwordx4 v[128:131], v3, s[36:39], s74 offen offset:128 nt
  buffer_load_dwordx4 v[132:135], v3, s[36:39], s74 offen offset:192 nt
  buffer_load_dwordx4 v[136:139], v4, s[40:43], s74 offen offset:0 nt
  buffer_load_dwordx4 v[140:143], v4, s[40:43], s74 offen offset:256 nt
  buffer_load_dwordx4 v[144:147], v4, s[40:43], s74 offen offset:512 nt
  buffer_load_dwordx4 v[148:151], v4, s[40:43], s74 offen offset:768 nt
  s_add_u32 m0, s71, 4096
  s_add_u32 s61, s83, 32768
  buffer_load_dwordx4 v251, s[44:47], s61 offen lds
  s_add_u32 m0, s71, 5120
  s_add_u32 s61, s83, 40960
  buffer_load_dwordx4 v251, s[44:47], s61 offen lds
  s_waitcnt vmcnt(34)
  v_dot2_f32_bf16 v48, v152, v52, 0
  v_dot2_f32_bf16 v49, v156, v52, 0
  v_dot2_f32_bf16 v50, v160, v52, 0
  v_dot2_f32_bf16 v51, v164, v52, 0
  v_dot2_f32_bf16 v48, v153, v53, v48
  v_dot2_f32_bf16 v49, v157, v53, v49
  v_dot2_f32_bf16 v50, v161, v53, v50
  v_dot2_f32_bf16 v51, v165, v53, v51
  v_dot2_f32_bf16 v48, v154, v54, v48
  v_dot2_f32_bf16 v49, v158, v54, v49
  v_dot2_f32_bf16 v50, v162, v54, v50
  v_dot2_f32_bf16 v51, v166, v54, v51
  v_dot2_f32_bf16 v48, v155, v55, v48
  v_dot2_f32_bf16 v49, v159, v55, v49
  v_dot2_f32_bf16 v50, v163, v55, v50
  v_dot2_f32_bf16 v51, v167, v55, v51
  s_nop 0
  v_add_f32_dpp v48, v48, v48 row_ror:8 row_mask:0xf bank_mask:0xf
  v_add_f32_dpp v49, v49, v49 row_ror:8 row_mask:0xf bank_mask:0xf
  v_add_f32_dpp v50, v50, v50 row_ror:8 row_mask:0xf bank_mask:0xf
  v_add_f32_dpp v51, v51, v51 row_ror:8 row_mask:0xf bank_mask:0xf
  v_add_f32_dpp v48, v48, v48 row_ror:4 row_mask:0xf bank_mask:0xf
  v_add_f32_dpp v49, v49, v49 row_ror:4 row_mask:0xf bank_mask:0xf
  v_add_f32_dpp v50, v50, v50 row_ror:4 row_mask:0xf bank_mask:0xf
  v_add_f32_dpp v51, v51, v51 row_ror:4 row_mask:0xf bank_mask:0xf
  v_add_f32_dpp v48, v48, v48 row_ror:2 row_mask:0xf bank_mask:0xf
  v_add_f32_dpp v49, v49, v49 row_ror:2 row_mask:0xf bank_mask:0xf
  v_add_f32_dpp v50, v50, v50 row_ror:2 row_mask:0xf bank_mask:0xf
  v_add_f32_dpp v51, v51, v51 row_ror:2 row_mask:0xf bank_mask:0xf
  v_add_f32_dpp v48, v48, v48 row_ror:1 row_mask:0xf bank_mask:0xf
  v_add_f32_dpp v49, v49, v49 row_ror:1 row_mask:0xf bank_mask:0xf
  v_add_f32_dpp v50, v50, v50 row_ror:1 row_mask:0xf bank_mask:0xf
  v_add_f32_dpp v51, v51, v51 row_ror:1 row_mask:0xf bank_mask:0xf
  s_waitcnt vmcnt(30)
  v_cvt_pk_bf16_f32 v16, v48, v49
  v_lshlrev_b32 v48, 16, v16
  v_and_b32 v49, 0xffff0000, v16
  v_mul_f32 v48, s68, v48
  v_mul_f32 v49, s68, v49
  v_cvt_pk_bf16_f32 v16, v48, v49
  v_lshlrev_b32 v48, 16, v16
  v_and_b32 v49, 0xffff0000, v16
  v_cvt_pk_bf16_f32 v16, v50, v51
  v_lshlrev_b32 v50, 16, v16
  v_and_b32 v51, 0xffff0000, v16
  v_mul_f32 v50, s68, v50
  v_mul_f32 v51, s68, v51
  v_cvt_pk_bf16_f32 v16, v50, v51
  v_lshlrev_b32 v50, 16, v16
  v_and_b32 v51, 0xffff0000, v16
  v_max3_f32 v8, v48, v49, v5
  v_max3_f32 v8, v50, v51, v8
  v_sub_f32 v9, v5, v8
  v_mul_f32 v10, s67, v8
  v_mul_f32 v9, s67, v9
  v_fma_f32 v12, v48, s67, -v10
  v_fma_f32 v13, v49, s67, -v10
  v_fma_f32 v14, v50, s67, -v10
  v_fma_f32 v15, v51, s67, -v10
  v_exp_f32 v9, v9
  v_exp_f32 v12, v12
  v_exp_f32 v13, v13
  v_exp_f32 v14, v14
  v_exp_f32 v15, v15
  v_mov_b32 v5, v8
  v_mul_f32 v40, v9, v40
  v_mul_f32 v41, v9, v41
  v_mul_f32 v42, v9, v42
  v_mul_f32 v43, v9, v43
  v_mul_f32 v44, v9, v44
  v_mul_f32 v45, v9, v45
  v_mul_f32 v46, v9, v46
  v_mul_f32 v47, v9, v47
  v_cvt_pk_bf16_f32 v18, v12, v13
  v_cvt_pk_bf16_f32 v19, v14, v15
  v_add_f32 v16, v12, v13
  v_add_f32 v17, v14, v15
  v_add_f32 v16, v16, v17
  v_fma_f32 v6, v6, v9, v16
  v_perm_b32 v20, v172, v168, s65
  v_perm_b32 v21, v172, v168, s66
  v_dot2_f32_bf16 v40, v20, v18, v40
  v_dot2_f32_bf16 v41, v21, v18, v41
  v_perm_b32 v22, v173, v169, s65
  v_perm_b32 v11, v173, v169, s66
  v_dot2_f32_bf16 v42, v22, v18, v42
  v_dot2_f32_bf16 v43, v11, v18, v43
  v_perm_b32 v20, v174, v170, s65
  v_perm_b32 v21, v174, v170, s66
  v_dot2_f32_bf16 v44, v20, v18, v44
  v_dot2_f32_bf16 v45, v21, v18, v45
  v_perm_b32 v22, v175, v171, s65
  v_perm_b32 v11, v175, v171, s66
  v_dot2_f32_bf16 v46, v22, v18, v46
  v_dot2_f32_bf16 v47, v11, v18, v47
  v_perm_b32 v20, v180, v176, s65
  v_perm_b32 v21, v180, v176, s66
  v_dot2_f32_bf16 v40, v20, v19, v40
  v_dot2_f32_bf16 v41, v21, v19, v41
  v_perm_b32 v22, v181, v177, s65
  v_perm_b32 v11, v181, v177, s66
  v_dot2_f32_bf16 v42, v22, v19, v42
  v_dot2_f32_bf16 v43, v11, v19, v43
  v_perm_b32 v20, v182, v178, s65
  v_perm_b32 v21, v182, v178, s66
  v_dot2_f32_bf16 v44, v20, v19, v44
  v_dot2_f32_bf16 v45, v21, v19, v45
  v_perm_b32 v22, v183, v179, s65
  v_perm_b32 v11, v183, v179, s66
  v_dot2_f32_bf16 v46, v22, v19, v46
  v_dot2_f32_bf16 v47, v11, v19, v47
  s_cmp_eq_u32 s72, 0x40000000
  s_cbranch_scc1 L1_exit
  s_waitcnt lgkmcnt(0)
  v_readfirstlane_b32 s61, v23
  s_lshr_b32 s12, s61, 2
  s_lshl_b32 s13, s12, 2
  s_add_u32 s13, s13, s64
  s_sub_u32 s14, s12, s8
  s_add_u32 s14, s14, s9
  s_cmp_lt_u32 s12, s8
  s_cselect_b32 s13, s13, s14
  s_lshl_b32 s13, s13, 14
  s_and_b32 s12, s61, 3
  s_lshl_b32 s12, s12, 12
  s_add_u32 s13, s13, s12
  s_add_u32 s13, s13, s60
  s_cmp_lt_u32 s61, s10
  s_cselect_b32 s75, s13, 0x40000000
  s_mov_b64 exec, 1
  ds_add_rtn_u32 v23, v249, v250 offset:8328
  s_mov_b64 exec, -1
  buffer_load_dwordx4 v[152:155], v4, s[36:39], s75 offen offset:0 nt
  buffer_load_dwordx4 v[156:159], v4, s[36:39], s75 offen offset:256 nt
  buffer_load_dwordx4 v[160:163], v4, s[36:39], s75 offen offset:512 nt
  buffer_load_dwordx4 v[164:167], v4, s[36:39], s75 offen offset:768 nt
  buffer_load_dwordx4 v[168:171], v4, s[40:43], s75 offen offset:0 nt
  buffer_load_dwordx4 v[172:175], v4, s[40:43], s75 offen offset:256 nt
  buffer_load_dwordx4 v[176:179], v4, s[40:43], s75 offen offset:512 nt
  buffer_load_dwordx4 v[180:183], v4, s[40:43], s75 offen offset:768 nt
  s_add_u32 m0, s71, 6144
  s_add_u32 s61, s83, 49152
  buffer_load_dwordx4 v251, s[44:47], s61 offen lds
  s_add_u32 m0, s71, 7168
  s_add_u32 s61, s83, 57344
  buffer_load_dwordx4 v251, s[44:47], s61 offen lds
  s_waitcnt vmcnt(36)
  v_mfma_f32_16x16x32_bf16 v[48:51], v[56:59], v[24:27], 0
  v_mfma_f32_16x16x32_bf16 v[48:51], v[60:63], v[28:31], v[48:51]
  v_mfma_f32_16x16x32_bf16 v[48:51], v[64:67], v[32:35], v[48:51]
  v_mfma_f32_16x16x32_bf16 v[48:51], v[68:71], v[36:39], v[48:51]
  s_nop 7
  s_waitcnt vmcnt(32)
  v_cvt_pk_bf16_f32 v16, v48, v49
  v_lshlrev_b32 v48, 16, v16
  v_and_b32 v49, 0xffff0000, v16
  v_mul_f32 v48, s68, v48
  v_mul_f32 v49, s68, v49
  v_cvt_pk_bf16_f32 v16, v48, v49
  v_lshlrev_b32 v48, 16, v16
  v_and_b32 v49, 0xffff0000, v16
  v_cvt_pk_bf16_f32 v16, v50, v51
  v_lshlrev_b32 v50, 16, v16
  v_and_b32 v51, 0xffff0000, v16
  v_mul_f32 v50, s68, v50
  v_mul_f32 v51, s68, v51
  v_cvt_pk_bf16_f32 v16, v50, v51
  v_lshlrev_b32 v50, 16, v16
  v_and_b32 v51, 0xffff0000, v16
  v_max3_f32 v8, v48, v49, v5
  v_max3_f32 v8, v50, v51, v8
  v_sub_f32 v9, v5, v8
  v_mul_f32 v10, s67, v8
  v_mul_f32 v9, s67, v9
  v_fma_f32 v12, v48, s67, -v10
  v_fma_f32 v13, v49, s67, -v10
  v_fma_f32 v14, v50, s67, -v10
  v_fma_f32 v15, v51, s67, -v10
  v_exp_f32 v9, v9
  v_exp_f32 v12, v12
  v_exp_f32 v13, v13
  v_exp_f32 v14, v14
  v_exp_f32 v15, v15
  v_mov_b32 v5, v8
  v_mul_f32 v40, v9, v40
  v_mul_f32 v41, v9, v41
  v_mul_f32 v42, v9, v42
  v_mul_f32 v43, v9, v43
  v_mul_f32 v44, v9, v44
  v_mul_f32 v45, v9, v45
  v_mul_f32 v46, v9, v46
  v_mul_f32 v47, v9, v47
  v_cvt_pk_bf16_f32 v18, v12, v13
  v_cvt_pk_bf16_f32 v19, v14, v15
  v_add_f32 v16, v12, v13
  v_add_f32 v17, v14, v15
  v_add_f32 v16, v16, v17
  v_fma_f32 v6, v6, v9, v16
  v_perm_b32 v20, v76, v72, s65
  v_perm_b32 v21, v76, v72, s66
  v_dot2_f32_bf16 v40, v20, v18, v40
  v_dot2_f32_bf16 v41, v21, v18, v41
  v_perm_b32 v22, v77, v73, s65
  v_perm_b32 v11, v77, v73, s66
  v_dot2_f32_bf16 v42, v22, v18, v42
  v_dot2_f32_bf16 v43, v11, v18, v43
  v_perm_b32 v20, v78, v74, s65
  v_perm_b32 v21, v78, v74, s66
  v_dot2_f32_bf16 v44, v20, v18, v44
  v_dot2_f32_bf16 v45, v21, v18, v45
  v_perm_b32 v22, v79, v75, s65
  v_perm_b32 v11, v79, v75, s66
  v_dot2_f32_bf16 v46, v22, v18, v46
  v_dot2_f32_bf16 v47, v11, v18, v47
  v_perm_b32 v20, v84, v80, s65
  v_perm_b32 v21, v84, v80, s66
  v_dot2_f32_bf16 v40, v20, v19, v40
  v_dot2_f32_bf16 v41, v21, v19, v41
  v_perm_b32 v22, v85, v81, s65
  v_perm_b32 v11, v85, v81, s66
  v_dot2_f32_bf16 v42, v22, v19, v42
  v_dot2_f32_bf16 v43, v11, v19, v43
  v_perm_b32 v20, v86, v82, s65
  v_perm_b32 v21, v86, v82, s66
  v_dot2_f32_bf16 v44, v20, v19, v44
  v_dot2_f32_bf16 v45, v21, v19, v45
  v_perm_b32 v22, v87, v83, s65
  v_perm_b32 v11, v87, v83, s66
  v_dot2_f32_bf16 v46, v22, v19, v46
  v_dot2_f32_bf16 v47, v11, v19, v47
  s_cmp_eq_u32 s73, 0x40000000
  s_cbranch_scc1 L1_exit
  s_waitcnt lgkmcnt(0)
  v_readfirstlane_b32 s61, v23
  s_lshr_b32 s12, s61, 2
  s_lshl_b32 s13, s12, 2
  s_add_u32 s13, s13, s64
  s_sub_u32 s14, s12, s8
  s_add_u32 s14, s14, s9
  s_cmp_lt_u32 s12, s8
  s_cselect_b32 s13, s13, s14
  s_lshl_b32 s13, s13, 14
  s_and_b32 s12, s61, 3
  s_lshl_b32 s12, s12, 12
  s_add_u32 s13, s13, s12
  s_add_u32 s13, s13, s60
  s_cmp_lt_u32 s61, s10
  s_cselect_b32 s72, s13, 0x40000000
  s_mov_b64 exec, 1
  ds_add_rtn_u32 v23, v249, v250 offset:8328
  s_mov_b64 exec, -1
  buffer_load_dwordx4 v[56:59], v3, s[36:39], s72 offen offset:0 nt
  buffer_load_dwordx4 v[60:63], v3, s[36:39], s72 offen offset:64 nt
  buffer_load_dwordx4 v[64:67], v3, s[36:39], s72 offen offset:128 nt
  buffer_load_dwordx4 v[68:71], v3, s[36:39], s72 offen offset:192 nt
  buffer_load_dwordx4 v[72:75], v4, s[40:43], s72 offen offset:0 nt
  buffer_load_dwordx4 v[76:79], v4, s[40:43], s72 offen offset:256 nt
  buffer_load_dwordx4 v[80:83], v4, s[40:43], s72 offen offset:512 nt
  buffer_load_dwordx4 v[84:87], v4, s[40:43], s72 offen offset:768 nt
  s_add_u32 m0, s71, 8192
  s_add_u32 s61, s83, 65536
  buffer_load_dwordx4 v251, s[44:47], s61 offen lds
  s_add_u32 m0, s71, 9216
  s_add_u32 s61, s83, 73728
  buffer_load_dwordx4 v251, s[44:47], s61 offen lds
  s_waitcnt vmcnt(36)
  v_dot2_f32_bf16 v48, v88, v52, 0
  v_dot2_f32_bf16 v49, v92, v52, 0
  v_dot2_f32_bf16 v50, v96, v52, 0
  v_dot2_f32_bf16 v51, v100, v52, 0
  v_dot2_f32_bf16 v48, v89, v53, v48
  v_dot2_f32_bf16 v49, v93, v53, v49
  v_dot2_f32_bf16 v50, v97, v53, v50
  v_dot2_f32_bf16 v51, v101, v53, v51
  v_dot2_f32_bf16 v48, v90, v54, v48
  v_dot2_f32_bf16 v49, v94, v54, v49
  v_dot2_f32_bf16 v50, v98, v54, v50
  v_dot2_f32_bf16 v51, v102, v54, v51
  v_dot2_f32_bf16 v48, v91, v55, v48
  v_dot2_f32_bf16 v49, v95, v55, v49
  v_dot2_f32_bf16 v50, v99, v55, v50
  v_dot2_f32_bf16 v51, v103, v55, v51
  s_nop 0
  v_add_f32_dpp v48, v48, v48 row_ror:8 row_mask:0xf bank_mask:0xf
  v_add_f32_dpp v49, v49, v49 row_ror:8 row_mask:0xf bank_mask:0xf
  v_add_f32_dpp v50, v50, v50 row_ror:8 row_mask:0xf bank_mask:0xf
  v_add_f32_dpp v51, v51, v51 row_ror:8 row_mask:0xf bank_mask:0xf
  v_add_f32_dpp v48, v48, v48 row_ror:4 row_mask:0xf bank_mask:0xf
  v_add_f32_dpp v49, v49, v49 row_ror:4 row_mask:0xf bank_mask:0xf
  v_add_f32_dpp v50, v50, v50 row_ror:4 row_mask:0xf bank_mask:0xf
  v_add_f32_dpp v51, v51, v51 row_ror:4 row_mask:0xf bank_mask:0xf
  v_add_f32_dpp v48, v48, v48 row_ror:2 row_mask:0xf bank_mask:0xf
  v_add_f32_dpp v49, v49, v49 row_ror:2 row_mask:0xf bank_mask:0xf
  v_add_f32_dpp v50, v50, v50 row_ror:2 row_mask:0xf bank_mask:0xf
  v_add_f32_dpp v51, v51, v51 row_ror:2 row_mask:0xf bank_mask:0xf
  v_add_f32_dpp v48, v48, v48 row_ror:1 row_mask:0xf bank_mask:0xf
  v_add_f32_dpp v49, v49, v49 row_ror:1 row_mask:0xf bank_mask:0xf
  v_add_f32_dpp v50, v50, v50 row_ror:1 row_mask:0xf bank_mask:0xf
  v_add_f32_dpp v51, v51, v51 row_ror:1 row_mask:0xf bank_mask:0xf
  s_waitcnt vmcnt(32)
  v_cvt_pk_bf16_f32 v16, v48, v49
  v_lshlrev_b32 v48, 16, v16
  v_and_b32 v49, 0xffff0000, v16
  v_mul_f32 v48, s68, v48
  v_mul_f32 v49, s68, v49
  v_cvt_pk_bf16_f32 v16, v48, v49
  v_lshlrev_b32 v48, 16, v16
  v_and_b32 v49, 0xffff0000, v16
  v_cvt_pk_bf16_f32 v16, v50, v51
  v_lshlrev_b32 v50, 16, v16
  v_and_b32 v51, 0xffff0000, v16
  v_mul_f32 v50, s68, v50
  v_mul_f32 v51, s68, v51
  v_cvt_pk_bf16_f32 v16, v50, v51
  v_lshlrev_b32 v50, 16, v16
  v_and_b32 v51, 0xffff0000, v16
  v_max3_f32 v8, v48, v49, v5
  v_max3_f32 v8, v50, v51, v8
  v_sub_f32 v9, v5, v8
  v_mul_f32 v10, s67, v8
  v_mul_f32 v9, s67, v9
  v_fma_f32 v12, v48, s67, -v10
  v_fma_f32 v13, v49, s67, -v10
  v_fma_f32 v14, v50, s67, -v10
  v_fma_f32 v15, v51, s67, -v10
  v_exp_f32 v9, v9
  v_exp_f32 v12, v12
  v_exp_f32 v13, v13
  v_exp_f32 v14, v14
  v_exp_f32 v15, v15
  v_mov_b32 v5, v8
  v_mul_f32 v40, v9, v40
  v_mul_f32 v41, v9, v41
  v_mul_f32 v42, v9, v42
  v_mul_f32 v43, v9, v43
  v_mul_f32 v44, v9, v44
  v_mul_f32 v45, v9, v45
  v_mul_f32 v46, v9, v46
  v_mul_f32 v47, v9, v47
  v_cvt_pk_bf16_f32 v18, v12, v13
  v_cvt_pk_bf16_f32 v19, v14, v15
  v_add_f32 v16, v12, v13
  v_add_f32 v17, v14, v15
  v_add_f32 v16, v16, v17
  v_fma_f32 v6, v6, v9, v16
  v_perm_b32 v20, v108, v104, s65
  v_perm_b32 v21, v108, v104, s66
  v_dot2_f32_bf16 v40, v20, v18, v40
  v_dot2_f32_bf16 v41, v21, v18, v41
  v_perm_b32 v22, v109, v105, s65
  v_perm_b32 v11, v109, v105, s66
  v_dot2_f32_bf16 v42, v22, v18, v42
  v_dot2_f32_bf16 v43, v11, v18, v43
  v_perm_b32 v20, v110, v106, s65
  v_perm_b32 v21, v110, v106, s66
  v_dot2_f32_bf16 v44, v20, v18, v44
  v_dot2_f32_bf16 v45, v21, v18, v45
  v_perm_b32 v22, v111, v107, s65
  v_perm_b32 v11, v111, v107, s66
  v_dot2_f32_bf16 v46, v22, v18, v46
  v_dot2_f32_bf16 v47, v11, v18, v47
  v_perm_b32 v20, v116, v112, s65
  v_perm_b32 v21, v116, v112, s66
  v_dot2_f32_bf16 v40, v20, v19, v40
  v_dot2_f32_bf16 v41, v21, v19, v41
  v_perm_b32 v22, v117, v113, s65
  v_perm_b32 v11, v117, v113, s66
  v_dot2_f32_bf16 v42, v22, v19, v42
  v_dot2_f32_bf16 v43, v11, v19, v43
  v_perm_b32 v20, v118, v114, s65
  v_perm_b32 v21, v118, v114, s66
  v_dot2_f32_bf16 v44, v20, v19, v44
  v_dot2_f32_bf16 v45, v21, v19, v45
  v_perm_b32 v22, v119, v115, s65
  v_perm_b32 v11, v119, v115, s66
  v_dot2_f32_bf16 v46, v22, v19, v46
  v_dot2_f32_bf16 v47, v11, v19, v47
  s_cmp_eq_u32 s74, 0x40000000
  s_cbranch_scc1 L1_exit
  s_waitcnt lgkmcnt(0)
  v_readfirstlane_b32 s61, v23
  s_lshr_b32 s12, s61, 2
  s_lshl_b32 s13, s12, 2
  s_add_u32 s13, s13, s64
  s_sub_u32 s14, s12, s8
  s_add_u32 s14, s14, s9
  s_cmp_lt_u32 s12, s8
  s_cselect_b32 s13, s13, s14
  s_lshl_b32 s13, s13, 14
  s_and_b32 s12, s61, 3
  s_lshl_b32 s12, s12, 12
  s_add_u32 s13, s13, s12
  s_add_u32 s13, s13, s60
  s_cmp_lt_u32 s61, s10
  s_cselect_b32 s73, s13, 0x40000000
  s_mov_b64 exec, 1
  ds_add_rtn_u32 v23, v249, v250 offset:8328
  s_mov_b64 exec, -1
  buffer_load_dwordx4 v[88:91], v4, s[36:39], s73 offen offset:0 nt
  buffer_load_dwordx4 v[92:95], v4, s[36:39], s73 offen offset:256 nt
  buffer_load_dwordx4 v[96:99], v4, s[36:39], s73 offen offset:512 nt
  buffer_load_dwordx4 v[100:103], v4, s[36:39], s73 offen offset:768 nt
  buffer_load_dwordx4 v[104:107], v4, s[40:43], s73 offen offset:0 nt
  buffer_load_dwordx4 v[108:111], v4, s[40:43], s73 offen offset:256 nt
  buffer_load_dwordx4 v[112:115], v4, s[40:43], s73 offen offset:512 nt
  buffer_load_dwordx4 v[116:119], v4, s[40:43], s73 offen offset:768 nt
  s_add_u32 m0, s71, 10240
  s_add_u32 s61, s83, 81920
  buffer_load_dwordx4 v251, s[44:47], s61 offen lds
  s_add_u32 m0, s71, 11264
  s_add_u32 s61, s83, 90112
  buffer_load_dwordx4 v251, s[44:47], s61 offen lds
  s_waitcnt vmcnt(36)
  v_mfma_f32_16x16x32_bf16 v[48:51], v[120:123], v[24:27], 0
  v_mfma_f32_16x16x32_bf16 v[48:51], v[124:127], v[28:31], v[48:51]
  v_mfma_f32_16x16x32_bf16 v[48:51], v[128:131], v[32:35], v[48:51]
  v_mfma_f32_16x16x32_bf16 v[48:51], v[132:135], v[36:39], v[48:51]
  s_nop 7
  s_waitcnt vmcnt(32)
  v_cvt_pk_bf16_f32 v16, v48, v49
  v_lshlrev_b32 v48, 16, v16
  v_and_b32 v49, 0xffff0000, v16
  v_mul_f32 v48, s68, v48
  v_mul_f32 v49, s68, v49
  v_cvt_pk_bf16_f32 v16, v48, v49
  v_lshlrev_b32 v48, 16, v16
  v_and_b32 v49, 0xffff0000, v16
  v_cvt_pk_bf16_f32 v16, v50, v51
  v_lshlrev_b32 v50, 16, v16
  v_and_b32 v51, 0xffff0000, v16
  v_mul_f32 v50, s68, v50
  v_mul_f32 v51, s68, v51
  v_cvt_pk_bf16_f32 v16, v50, v51
  v_lshlrev_b32 v50, 16, v16
  v_and_b32 v51, 0xffff0000, v16
  v_max3_f32 v8, v48, v49, v5
  v_max3_f32 v8, v50, v51, v8
  v_sub_f32 v9, v5, v8
  v_mul_f32 v10, s67, v8
  v_mul_f32 v9, s67, v9
  v_fma_f32 v12, v48, s67, -v10
  v_fma_f32 v13, v49, s67, -v10
  v_fma_f32 v14, v50, s67, -v10
  v_fma_f32 v15, v51, s67, -v10
  v_exp_f32 v9, v9
  v_exp_f32 v12, v12
  v_exp_f32 v13, v13
  v_exp_f32 v14, v14
  v_exp_f32 v15, v15
  v_mov_b32 v5, v8
  v_mul_f32 v40, v9, v40
  v_mul_f32 v41, v9, v41
  v_mul_f32 v42, v9, v42
  v_mul_f32 v43, v9, v43
  v_mul_f32 v44, v9, v44
  v_mul_f32 v45, v9, v45
  v_mul_f32 v46, v9, v46
  v_mul_f32 v47, v9, v47
  v_cvt_pk_bf16_f32 v18, v12, v13
  v_cvt_pk_bf16_f32 v19, v14, v15
  v_add_f32 v16, v12, v13
  v_add_f32 v17, v14, v15
  v_add_f32 v16, v16, v17
  v_fma_f32 v6, v6, v9, v16
  v_perm_b32 v20, v140, v136, s65
  v_perm_b32 v21, v140, v136, s66
  v_dot2_f32_bf16 v40, v20, v18, v40
  v_dot2_f32_bf16 v41, v21, v18, v41
  v_perm_b32 v22, v141, v137, s65
  v_perm_b32 v11, v141, v137, s66
  v_dot2_f32_bf16 v42, v22, v18, v42
  v_dot2_f32_bf16 v43, v11, v18, v43
  v_perm_b32 v20, v142, v138, s65
  v_perm_b32 v21, v142, v138, s66
  v_dot2_f32_bf16 v44, v20, v18, v44
  v_dot2_f32_bf16 v45, v21, v18, v45
  v_perm_b32 v22, v143, v139, s65
  v_perm_b32 v11, v143, v139, s66
  v_dot2_f32_bf16 v46, v22, v18, v46
  v_dot2_f32_bf16 v47, v11, v18, v47
  v_perm_b32 v20, v148, v144, s65
  v_perm_b32 v21, v148, v144, s66
  v_dot2_f32_bf16 v40, v20, v19, v40
  v_dot2_f32_bf16 v41, v21, v19, v41
  v_perm_b32 v22, v149, v145, s65
  v_perm_b32 v11, v149, v145, s66
  v_dot2_f32_bf16 v42, v22, v19, v42
  v_dot2_f32_bf16 v43, v11, v19, v43
  v_perm_b32 v20, v150, v146, s65
  v_perm_b32 v21, v150, v146, s66
  v_dot2_f32_bf16 v44, v20, v19, v44
  v_dot2_f32_bf16 v45, v21, v19, v45
  v_perm_b32 v22, v151, v147, s65
  v_perm_b32 v11, v151, v147, s66
  v_dot2_f32_bf16 v46, v22, v19, v46
  v_dot2_f32_bf16 v47, v11, v19, v47
  s_cmp_eq_u32 s75, 0x40000000
  s_cbranch_scc1 L1_exit
  s_waitcnt lgkmcnt(0)
  v_readfirstlane_b32 s61, v23
  s_lshr_b32 s12, s61, 2
  s_lshl_b32 s13, s12, 2
  s_add_u32 s13, s13, s64
  s_sub_u32 s14, s12, s8
  s_add_u32 s14, s14, s9
  s_cmp_lt_u32 s12, s8
  s_cselect_b32 s13, s13, s14
  s_lshl_b32 s13, s13, 14
  s_and_b32 s12, s61, 3
  s_lshl_b32 s12, s12, 12
  s_add_u32 s13, s13, s12
  s_add_u32 s13, s13, s60
  s_cmp_lt_u32 s61, s10
  s_cselect_b32 s74, s13, 0x40000000
  s_mov_b64 exec, 1
  ds_add_rtn_u32 v23, v249, v250 offset:8328
  s_mov_b64 exec, -1
  buffer_load_dwordx4 v[120:123], v3, s[36:39], s74 offen offset:0 nt
  buffer_load_dwordx4 v[124:127], v3, s[36:39], s74 offen offset:64 nt
  buffer_load_dwordx4 v[128:131], v3, s[36:39], s74 offen offset:128 nt
  buffer_load_dwordx4 v[132:135], v3, s[36:39], s74 offen offset:192 nt
  buffer_load_dwordx4 v[136:139], v4, s[40:43], s74 offen offset:0 nt
  buffer_load_dwordx4 v[140:143], v4, s[40:43], s74 offen offset:256 nt
  buffer_load_dwordx4 v[144:147], v4, s[40:43], s74 offen offset:512 nt
  buffer_load_dwordx4 v[148:151], v4, s[40:43], s74 offen offset:768 nt
  s_add_u32 m0, s71, 12288
  s_add_u32 s61, s83, 98304
  buffer_load_dwordx4 v251, s[44:47], s61 offen lds
  s_add_u32 m0, s71, 13312
  s_add_u32 s61, s83, 106496
  buffer_load_dwordx4 v251, s[44:47], s61 offen lds
  s_waitcnt vmcnt(36)
  v_dot2_f32_bf16 v48, v152, v52, 0
  v_dot2_f32_bf16 v49, v156, v52, 0
  v_dot2_f32_bf16 v50, v160, v52, 0
  v_dot2_f32_bf16 v51, v164, v52, 0
  v_dot2_f32_bf16 v48, v153, v53, v48
  v_dot2_f32_bf16 v49, v157, v53, v49
  v_dot2_f32_bf16 v50, v161, v53, v50
  v_dot2_f32_bf16 v51, v165, v53, v51
  v_dot2_f32_bf16 v48, v154, v54, v48
  v_dot2_f32_bf16 v49, v158, v54, v49
  v_dot2_f32_bf16 v50, v162, v54, v50
  v_dot2_f32_bf16 v51, v166, v54, v51
  v_dot2_f32_bf16 v48, v155, v55, v48
  v_dot2_f32_bf16 v49, v159, v55, v49
  v_dot2_f32_bf16 v50, v163, v55, v50
  v_dot2_f32_bf16 v51, v167, v55, v51
  s_nop 0
  v_add_f32_dpp v48, v48, v48 row_ror:8 row_mask:0xf bank_mask:0xf
  v_add_f32_dpp v49, v49, v49 row_ror:8 row_mask:0xf bank_mask:0xf
  v_add_f32_dpp v50, v50, v50 row_ror:8 row_mask:0xf bank_mask:0xf
  v_add_f32_dpp v51, v51, v51 row_ror:8 row_mask:0xf bank_mask:0xf
  v_add_f32_dpp v48, v48, v48 row_ror:4 row_mask:0xf bank_mask:0xf
  v_add_f32_dpp v49, v49, v49 row_ror:4 row_mask:0xf bank_mask:0xf
  v_add_f32_dpp v50, v50, v50 row_ror:4 row_mask:0xf bank_mask:0xf
  v_add_f32_dpp v51, v51, v51 row_ror:4 row_mask:0xf bank_mask:0xf
  v_add_f32_dpp v48, v48, v48 row_ror:2 row_mask:0xf bank_mask:0xf
  v_add_f32_dpp v49, v49, v49 row_ror:2 row_mask:0xf bank_mask:0xf
  v_add_f32_dpp v50, v50, v50 row_ror:2 row_mask:0xf bank_mask:0xf
  v_add_f32_dpp v51, v51, v51 row_ror:2 row_mask:0xf bank_mask:0xf
  v_add_f32_dpp v48, v48, v48 row_ror:1 row_mask:0xf bank_mask:0xf
  v_add_f32_dpp v49, v49, v49 row_ror:1 row_mask:0xf bank_mask:0xf
  v_add_f32_dpp v50, v50, v50 row_ror:1 row_mask:0xf bank_mask:0xf
  v_add_f32_dpp v51, v51, v51 row_ror:1 row_mask:0xf bank_mask:0xf
  s_waitcnt vmcnt(32)
  v_cvt_pk_bf16_f32 v16, v48, v49
  v_lshlrev_b32 v48, 16, v16
  v_and_b32 v49, 0xffff0000, v16
  v_mul_f32 v48, s68, v48
  v_mul_f32 v49, s68, v49
  v_cvt_pk_bf16_f32 v16, v48, v49
  v_lshlrev_b32 v48, 16, v16
  v_and_b32 v49, 0xffff0000, v16
  v_cvt_pk_bf16_f32 v16, v50, v51
  v_lshlrev_b32 v50, 16, v16
  v_and_b32 v51, 0xffff0000, v16
  v_mul_f32 v50, s68, v50
  v_mul_f32 v51, s68, v51
  v_cvt_pk_bf16_f32 v16, v50, v51
  v_lshlrev_b32 v50, 16, v16
  v_and_b32 v51, 0xffff0000, v16
  v_max3_f32 v8, v48, v49, v5
  v_max3_f32 v8, v50, v51, v8
  v_sub_f32 v9, v5, v8
  v_mul_f32 v10, s67, v8
  v_mul_f32 v9, s67, v9
  v_fma_f32 v12, v48, s67, -v10
  v_fma_f32 v13, v49, s67, -v10
  v_fma_f32 v14, v50, s67, -v10
  v_fma_f32 v15, v51, s67, -v10
  v_exp_f32 v9, v9
  v_exp_f32 v12, v12
  v_exp_f32 v13, v13
  v_exp_f32 v14, v14
  v_exp_f32 v15, v15
  v_mov_b32 v5, v8
  v_mul_f32 v40, v9, v40
  v_mul_f32 v41, v9, v41
  v_mul_f32 v42, v9, v42
  v_mul_f32 v43, v9, v43
  v_mul_f32 v44, v9, v44
  v_mul_f32 v45, v9, v45
  v_mul_f32 v46, v9, v46
  v_mul_f32 v47, v9, v47
  v_cvt_pk_bf16_f32 v18, v12, v13
  v_cvt_pk_bf16_f32 v19, v14, v15
  v_add_f32 v16, v12, v13
  v_add_f32 v17, v14, v15
  v_add_f32 v16, v16, v17
  v_fma_f32 v6, v6, v9, v16
  v_perm_b32 v20, v172, v168, s65
  v_perm_b32 v21, v172, v168, s66
  v_dot2_f32_bf16 v40, v20, v18, v40
  v_dot2_f32_bf16 v41, v21, v18, v41
  v_perm_b32 v22, v173, v169, s65
  v_perm_b32 v11, v173, v169, s66
  v_dot2_f32_bf16 v42, v22, v18, v42
  v_dot2_f32_bf16 v43, v11, v18, v43
  v_perm_b32 v20, v174, v170, s65
  v_perm_b32 v21, v174, v170, s66
  v_dot2_f32_bf16 v44, v20, v18, v44
  v_dot2_f32_bf16 v45, v21, v18, v45
  v_perm_b32 v22, v175, v171, s65
  v_perm_b32 v11, v175, v171, s66
  v_dot2_f32_bf16 v46, v22, v18, v46
  v_dot2_f32_bf16 v47, v11, v18, v47
  v_perm_b32 v20, v180, v176, s65
  v_perm_b32 v21, v180, v176, s66
  v_dot2_f32_bf16 v40, v20, v19, v40
  v_dot2_f32_bf16 v41, v21, v19, v41
  v_perm_b32 v22, v181, v177, s65
  v_perm_b32 v11, v181, v177, s66
  v_dot2_f32_bf16 v42, v22, v19, v42
  v_dot2_f32_bf16 v43, v11, v19, v43
  v_perm_b32 v20, v182, v178, s65
  v_perm_b32 v21, v182, v178, s66
  v_dot2_f32_bf16 v44, v20, v19, v44
  v_dot2_f32_bf16 v45, v21, v19, v45
  v_perm_b32 v22, v183, v179, s65
  v_perm_b32 v11, v183, v179, s66
  v_dot2_f32_bf16 v46, v22, v19, v46
  v_dot2_f32_bf16 v47, v11, v19, v47
  s_cmp_eq_u32 s72, 0x40000000
  s_cbranch_scc1 L1_exit
  s_waitcnt lgkmcnt(0)
  v_readfirstlane_b32 s61, v23
  s_lshr_b32 s12, s61, 2
  s_lshl_b32 s13, s12, 2
  s_add_u32 s13, s13, s64
  s_sub_u32 s14, s12, s8
  s_add_u32 s14, s14, s9
  s_cmp_lt_u32 s12, s8
  s_cselect_b32 s13, s13, s14
  s_lshl_b32 s13, s13, 14
  s_and_b32 s12, s61, 3
  s_lshl_b32 s12, s12, 12
  s_add_u32 s13, s13, s12
  s_add_u32 s13, s13, s60
  s_cmp_lt_u32 s61, s10
  s_cselect_b32 s75, s13, 0x40000000
  s_mov_b64 exec, 1
  ds_add_rtn_u32 v23, v249, v250 offset:8328
  s_mov_b64 exec, -1
  buffer_load_dwordx4 v[152:155], v4, s[36:39], s75 offen offset:0 nt
  buffer_load_dwordx4 v[156:159], v4, s[36:39], s75 offen offset:256 nt
  buffer_load_dwordx4 v[160:163], v4, s[36:39], s75 offen offset:512 nt
  buffer_load_dwordx4 v[164:167], v4, s[36:39], s75 offen offset:768 nt
  buffer_load_dwordx4 v[168:171], v4, s[40:43], s75 offen offset:0 nt
  buffer_load_dwordx4 v[172:175], v4, s[40:43], s75 offen offset:256 nt
  buffer_load_dwordx4 v[176:179], v4, s[40:43], s75 offen offset:512 nt
  buffer_load_dwordx4 v[180:183], v4, s[40:43], s75 offen offset:768 nt
  s_add_u32 m0, s71, 14336
  s_add_u32 s61, s83, 114688
  buffer_load_dwordx4 v251, s[44:47], s61 offen lds
  s_add_u32 m0, s71, 15360
  s_add_u32 s61, s83, 122880
  buffer_load_dwordx4 v251, s[44:47], s61 offen lds
  s_waitcnt vmcnt(36)
  v_mfma_f32_16x16x32_bf16 v[48:51], v[56:59], v[24:27], 0
  v_mfma_f32_16x16x32_bf16 v[48:51], v[60:63], v[28:31], v[48:51]
  v_mfma_f32_16x16x32_bf16 v[48:51], v[64:67], v[32:35], v[48:51]
  v_mfma_f32_16x16x32_bf16 v[48:51], v[68:71], v[36:39], v[48:51]
  s_nop 7
  s_waitcnt vmcnt(32)
  v_cvt_pk_bf16_f32 v16, v48, v49
  v_lshlrev_b32 v48, 16, v16
  v_and_b32 v49, 0xffff0000, v16
  v_mul_f32 v48, s68, v48
  v_mul_f32 v49, s68, v49
  v_cvt_pk_bf16_f32 v16, v48, v49
  v_lshlrev_b32 v48, 16, v16
  v_and_b32 v49, 0xffff0000, v16
  v_cvt_pk_bf16_f32 v16, v50, v51
  v_lshlrev_b32 v50, 16, v16
  v_and_b32 v51, 0xffff0000, v16
  v_mul_f32 v50, s68, v50
  v_mul_f32 v51, s68, v51
  v_cvt_pk_bf16_f32 v16, v50, v51
  v_lshlrev_b32 v50, 16, v16
  v_and_b32 v51, 0xffff0000, v16
  v_max3_f32 v8, v48, v49, v5
  v_max3_f32 v8, v50, v51, v8
  v_sub_f32 v9, v5, v8
  v_mul_f32 v10, s67, v8
  v_mul_f32 v9, s67, v9
  v_fma_f32 v12, v48, s67, -v10
  v_fma_f32 v13, v49, s67, -v10
  v_fma_f32 v14, v50, s67, -v10
  v_fma_f32 v15, v51, s67, -v10
  v_exp_f32 v9, v9
  v_exp_f32 v12, v12
  v_exp_f32 v13, v13
  v_exp_f32 v14, v14
  v_exp_f32 v15, v15
  v_mov_b32 v5, v8
  v_mul_f32 v40, v9, v40
  v_mul_f32 v41, v9, v41
  v_mul_f32 v42, v9, v42
  v_mul_f32 v43, v9, v43
  v_mul_f32 v44, v9, v44
  v_mul_f32 v45, v9, v45
  v_mul_f32 v46, v9, v46
  v_mul_f32 v47, v9, v47
  v_cvt_pk_bf16_f32 v18, v12, v13
  v_cvt_pk_bf16_f32 v19, v14, v15
  v_add_f32 v16, v12, v13
  v_add_f32 v17, v14, v15
  v_add_f32 v16, v16, v17
  v_fma_f32 v6, v6, v9, v16
  v_perm_b32 v20, v76, v72, s65
  v_perm_b32 v21, v76, v72, s66
  v_dot2_f32_bf16 v40, v20, v18, v40
  v_dot2_f32_bf16 v41, v21, v18, v41
  v_perm_b32 v22, v77, v73, s65
  v_perm_b32 v11, v77, v73, s66
  v_dot2_f32_bf16 v42, v22, v18, v42
  v_dot2_f32_bf16 v43, v11, v18, v43
  v_perm_b32 v20, v78, v74, s65
  v_perm_b32 v21, v78, v74, s66
  v_dot2_f32_bf16 v44, v20, v18, v44
  v_dot2_f32_bf16 v45, v21, v18, v45
  v_perm_b32 v22, v79, v75, s65
  v_perm_b32 v11, v79, v75, s66
  v_dot2_f32_bf16 v46, v22, v18, v46
  v_dot2_f32_bf16 v47, v11, v18, v47
  v_perm_b32 v20, v84, v80, s65
  v_perm_b32 v21, v84, v80, s66
  v_dot2_f32_bf16 v40, v20, v19, v40
  v_dot2_f32_bf16 v41, v21, v19, v41
  v_perm_b32 v22, v85, v81, s65
  v_perm_b32 v11, v85, v81, s66
  v_dot2_f32_bf16 v42, v22, v19, v42
  v_dot2_f32_bf16 v43, v11, v19, v43
  v_perm_b32 v20, v86, v82, s65
  v_perm_b32 v21, v86, v82, s66
  v_dot2_f32_bf16 v44, v20, v19, v44
  v_dot2_f32_bf16 v45, v21, v19, v45
  v_perm_b32 v22, v87, v83, s65
  v_perm_b32 v11, v87, v83, s66
  v_dot2_f32_bf16 v46, v22, v19, v46
  v_dot2_f32_bf16 v47, v11, v19, v47
  s_cmp_eq_u32 s73, 0x40000000
  s_cbranch_scc1 L1_exit
  s_waitcnt lgkmcnt(0)
  v_readfirstlane_b32 s61, v23
  s_lshr_b32 s12, s61, 2
  s_lshl_b32 s13, s12, 2
  s_add_u32 s13, s13, s64
  s_sub_u32 s14, s12, s8
  s_add_u32 s14, s14, s9
  s_cmp_lt_u32 s12, s8
  s_cselect_b32 s13, s13, s14
  s_lshl_b32 s13, s13, 14
  s_and_b32 s12, s61, 3
  s_lshl_b32 s12, s12, 12
  s_add_u32 s13, s13, s12
  s_add_u32 s13, s13, s60
  s_cmp_lt_u32 s61, s10
  s_cselect_b32 s72, s13, 0x40000000
  s_mov_b64 exec, 1
  ds_add_rtn_u32 v23, v249, v250 offset:8328
  s_mov_b64 exec, -1
  buffer_load_dwordx4 v[56:59], v3, s[36:39], s72 offen offset:0 nt
  buffer_load_dwordx4 v[60:63], v3, s[36:39], s72 offen offset:64 nt
  buffer_load_dwordx4 v[64:67], v3, s[36:39], s72 offen offset:128 nt
  buffer_load_dwordx4 v[68:71], v3, s[36:39], s72 offen offset:192 nt
  buffer_load_dwordx4 v[72:75], v4, s[40:43], s72 offen offset:0 nt
  buffer_load_dwordx4 v[76:79], v4, s[40:43], s72 offen offset:256 nt
  buffer_load_dwordx4 v[80:83], v4, s[40:43], s72 offen offset:512 nt
  buffer_load_dwordx4 v[84:87], v4, s[40:43], s72 offen offset:768 nt
  s_add_u32 m0, s71, 65536
  s_add_u32 s61, s83, 512
  buffer_load_dwordx4 v251, s[44:47], s61 offen lds
  s_add_u32 m0, s71, 66560
  s_add_u32 s61, s83, 8704
  buffer_load_dwordx4 v251, s[44:47], s61 offen lds
  s_waitcnt vmcnt(36)
  v_dot2_f32_bf16 v48, v88, v52, 0
  v_dot2_f32_bf16 v49, v92, v52, 0
  v_dot2_f32_bf16 v50, v96, v52, 0
  v_dot2_f32_bf16 v51, v100, v52, 0
  v_dot2_f32_bf16 v48, v89, v53, v48
  v_dot2_f32_bf16 v49, v93, v53, v49
  v_dot2_f32_bf16 v50, v97, v53, v50
  v_dot2_f32_bf16 v51, v101, v53, v51
  v_dot2_f32_bf16 v48, v90, v54, v48
  v_dot2_f32_bf16 v49, v94, v54, v49
  v_dot2_f32_bf16 v50, v98, v54, v50
  v_dot2_f32_bf16 v51, v102, v54, v51
  v_dot2_f32_bf16 v48, v91, v55, v48
  v_dot2_f32_bf16 v49, v95, v55, v49
  v_dot2_f32_bf16 v50, v99, v55, v50
  v_dot2_f32_bf16 v51, v103, v55, v51
  s_nop 0
  v_add_f32_dpp v48, v48, v48 row_ror:8 row_mask:0xf bank_mask:0xf
  v_add_f32_dpp v49, v49, v49 row_ror:8 row_mask:0xf bank_mask:0xf
  v_add_f32_dpp v50, v50, v50 row_ror:8 row_mask:0xf bank_mask:0xf
  v_add_f32_dpp v51, v51, v51 row_ror:8 row_mask:0xf bank_mask:0xf
  v_add_f32_dpp v48, v48, v48 row_ror:4 row_mask:0xf bank_mask:0xf
  v_add_f32_dpp v49, v49, v49 row_ror:4 row_mask:0xf bank_mask:0xf
  v_add_f32_dpp v50, v50, v50 row_ror:4 row_mask:0xf bank_mask:0xf
  v_add_f32_dpp v51, v51, v51 row_ror:4 row_mask:0xf bank_mask:0xf
  v_add_f32_dpp v48, v48, v48 row_ror:2 row_mask:0xf bank_mask:0xf
  v_add_f32_dpp v49, v49, v49 row_ror:2 row_mask:0xf bank_mask:0xf
  v_add_f32_dpp v50, v50, v50 row_ror:2 row_mask:0xf bank_mask:0xf
  v_add_f32_dpp v51, v51, v51 row_ror:2 row_mask:0xf bank_mask:0xf
  v_add_f32_dpp v48, v48, v48 row_ror:1 row_mask:0xf bank_mask:0xf
  v_add_f32_dpp v49, v49, v49 row_ror:1 row_mask:0xf bank_mask:0xf
  v_add_f32_dpp v50, v50, v50 row_ror:1 row_mask:0xf bank_mask:0xf
  v_add_f32_dpp v51, v51, v51 row_ror:1 row_mask:0xf bank_mask:0xf
  s_waitcnt vmcnt(32)
  v_cvt_pk_bf16_f32 v16, v48, v49
  v_lshlrev_b32 v48, 16, v16
  v_and_b32 v49, 0xffff0000, v16
  v_mul_f32 v48, s68, v48
  v_mul_f32 v49, s68, v49
  v_cvt_pk_bf16_f32 v16, v48, v49
  v_lshlrev_b32 v48, 16, v16
  v_and_b32 v49, 0xffff0000, v16
  v_cvt_pk_bf16_f32 v16, v50, v51
  v_lshlrev_b32 v50, 16, v16
  v_and_b32 v51, 0xffff0000, v16
  v_mul_f32 v50, s68, v50
  v_mul_f32 v51, s68, v51
  v_cvt_pk_bf16_f32 v16, v50, v51
  v_lshlrev_b32 v50, 16, v16
  v_and_b32 v51, 0xffff0000, v16
  v_max3_f32 v8, v48, v49, v5
  v_max3_f32 v8, v50, v51, v8
  v_sub_f32 v9, v5, v8
  v_mul_f32 v10, s67, v8
  v_mul_f32 v9, s67, v9
  v_fma_f32 v12, v48, s67, -v10
  v_fma_f32 v13, v49, s67, -v10
  v_fma_f32 v14, v50, s67, -v10
  v_fma_f32 v15, v51, s67, -v10
  v_exp_f32 v9, v9
  v_exp_f32 v12, v12
  v_exp_f32 v13, v13
  v_exp_f32 v14, v14
  v_exp_f32 v15, v15
  v_mov_b32 v5, v8
  v_mul_f32 v40, v9, v40
  v_mul_f32 v41, v9, v41
  v_mul_f32 v42, v9, v42
  v_mul_f32 v43, v9, v43
  v_mul_f32 v44, v9, v44
  v_mul_f32 v45, v9, v45
  v_mul_f32 v46, v9, v46
  v_mul_f32 v47, v9, v47
  v_cvt_pk_bf16_f32 v18, v12, v13
  v_cvt_pk_bf16_f32 v19, v14, v15
  v_add_f32 v16, v12, v13
  v_add_f32 v17, v14, v15
  v_add_f32 v16, v16, v17
  v_fma_f32 v6, v6, v9, v16
  v_perm_b32 v20, v108, v104, s65
  v_perm_b32 v21, v108, v104, s66
  v_dot2_f32_bf16 v40, v20, v18, v40
  v_dot2_f32_bf16 v41, v21, v18, v41
  v_perm_b32 v22, v109, v105, s65
  v_perm_b32 v11, v109, v105, s66
  v_dot2_f32_bf16 v42, v22, v18, v42
  v_dot2_f32_bf16 v43, v11, v18, v43
  v_perm_b32 v20, v110, v106, s65
  v_perm_b32 v21, v110, v106, s66
  v_dot2_f32_bf16 v44, v20, v18, v44
  v_dot2_f32_bf16 v45, v21, v18, v45
  v_perm_b32 v22, v111, v107, s65
  v_perm_b32 v11, v111, v107, s66
  v_dot2_f32_bf16 v46, v22, v18, v46
  v_dot2_f32_bf16 v47, v11, v18, v47
  v_perm_b32 v20, v116, v112, s65
  v_perm_b32 v21, v116, v112, s66
  v_dot2_f32_bf16 v40, v20, v19, v40
  v_dot2_f32_bf16 v41, v21, v19, v41
  v_perm_b32 v22, v117, v113, s65
  v_perm_b32 v11, v117, v113, s66
  v_dot2_f32_bf16 v42, v22, v19, v42
  v_dot2_f32_bf16 v43, v11, v19, v43
  v_perm_b32 v20, v118, v114, s65
  v_perm_b32 v21, v118, v114, s66
  v_dot2_f32_bf16 v44, v20, v19, v44
  v_dot2_f32_bf16 v45, v21, v19, v45
  v_perm_b32 v22, v119, v115, s65
  v_perm_b32 v11, v119, v115, s66
  v_dot2_f32_bf16 v46, v22, v19, v46
  v_dot2_f32_bf16 v47, v11, v19, v47
  s_cmp_eq_u32 s74, 0x40000000
  s_cbranch_scc1 L1_exit
  s_waitcnt lgkmcnt(0)
  v_readfirstlane_b32 s61, v23
  s_lshr_b32 s12, s61, 2
  s_lshl_b32 s13, s12, 2
  s_add_u32 s13, s13, s64
  s_sub_u32 s14, s12, s8
  s_add_u32 s14, s14, s9
  s_cmp_lt_u32 s12, s8
  s_cselect_b32 s13, s13, s14
  s_lshl_b32 s13, s13, 14
  s_and_b32 s12, s61, 3
  s_lshl_b32 s12, s12, 12
  s_add_u32 s13, s13, s12
  s_add_u32 s13, s13, s60
  s_cmp_lt_u32 s61, s10
  s_cselect_b32 s73, s13, 0x40000000
  s_mov_b64 exec, 1
  ds_add_rtn_u32 v23, v249, v250 offset:8328
  s_mov_b64 exec, -1
  buffer_load_dwordx4 v[88:91], v4, s[36:39], s73 offen offset:0 nt
  buffer_load_dwordx4 v[92:95], v4, s[36:39], s73 offen offset:256 nt
  buffer_load_dwordx4 v[96:99], v4, s[36:39], s73 offen offset:512 nt
  buffer_load_dwordx4 v[100:103], v4, s[36:39], s73 offen offset:768 nt
  buffer_load_dwordx4 v[104:107], v4, s[40:43], s73 offen offset:0 nt
  buffer_load_dwordx4 v[108:111], v4, s[40:43], s73 offen offset:256 nt
  buffer_load_dwordx4 v[112:115], v4, s[40:43], s73 offen offset:512 nt
  buffer_load_dwordx4 v[116:119], v4, s[40:43], s73 offen offset:768 nt
  s_add_u32 m0, s71, 67584
  s_add_u32 s61, s83, 16896
  buffer_load_dwordx4 v251, s[44:47], s61 offen lds
  s_add_u32 m0, s71, 68608
  s_add_u32 s61, s83, 25088
  buffer_load_dwordx4 v251, s[44:47], s61 offen lds
  s_waitcnt vmcnt(36)
  v_mfma_f32_16x16x32_bf16 v[48:51], v[120:123], v[24:27], 0
  v_mfma_f32_16x16x32_bf16 v[48:51], v[124:127], v[28:31], v[48:51]
  v_mfma_f32_16x16x32_bf16 v[48:51], v[128:131], v[32:35], v[48:51]
  v_mfma_f32_16x16x32_bf16 v[48:51], v[132:135], v[36:39], v[48:51]
  s_nop 7
  s_waitcnt vmcnt(32)
  v_cvt_pk_bf16_f32 v16, v48, v49
  v_lshlrev_b32 v48, 16, v16
  v_and_b32 v49, 0xffff0000, v16
  v_mul_f32 v48, s68, v48
  v_mul_f32 v49, s68, v49
  v_cvt_pk_bf16_f32 v16, v48, v49
  v_lshlrev_b32 v48, 16, v16
  v_and_b32 v49, 0xffff0000, v16
  v_cvt_pk_bf16_f32 v16, v50, v51
  v_lshlrev_b32 v50, 16, v16
  v_and_b32 v51, 0xffff0000, v16
  v_mul_f32 v50, s68, v50
  v_mul_f32 v51, s68, v51
  v_cvt_pk_bf16_f32 v16, v50, v51
  v_lshlrev_b32 v50, 16, v16
  v_and_b32 v51, 0xffff0000, v16
  v_max3_f32 v8, v48, v49, v5
  v_max3_f32 v8, v50, v51, v8
  v_sub_f32 v9, v5, v8
  v_mul_f32 v10, s67, v8
  v_mul_f32 v9, s67, v9
  v_fma_f32 v12, v48, s67, -v10
  v_fma_f32 v13, v49, s67, -v10
  v_fma_f32 v14, v50, s67, -v10
  v_fma_f32 v15, v51, s67, -v10
  v_exp_f32 v9, v9
  v_exp_f32 v12, v12
  v_exp_f32 v13, v13
  v_exp_f32 v14, v14
  v_exp_f32 v15, v15
  v_mov_b32 v5, v8
  v_mul_f32 v40, v9, v40
  v_mul_f32 v41, v9, v41
  v_mul_f32 v42, v9, v42
  v_mul_f32 v43, v9, v43
  v_mul_f32 v44, v9, v44
  v_mul_f32 v45, v9, v45
  v_mul_f32 v46, v9, v46
  v_mul_f32 v47, v9, v47
  v_cvt_pk_bf16_f32 v18, v12, v13
  v_cvt_pk_bf16_f32 v19, v14, v15
  v_add_f32 v16, v12, v13
  v_add_f32 v17, v14, v15
  v_add_f32 v16, v16, v17
  v_fma_f32 v6, v6, v9, v16
  v_perm_b32 v20, v140, v136, s65
  v_perm_b32 v21, v140, v136, s66
  v_dot2_f32_bf16 v40, v20, v18, v40
  v_dot2_f32_bf16 v41, v21, v18, v41
  v_perm_b32 v22, v141, v137, s65
  v_perm_b32 v11, v141, v137, s66
  v_dot2_f32_bf16 v42, v22, v18, v42
  v_dot2_f32_bf16 v43, v11, v18, v43
  v_perm_b32 v20, v142, v138, s65
  v_perm_b32 v21, v142, v138, s66
  v_dot2_f32_bf16 v44, v20, v18, v44
  v_dot2_f32_bf16 v45, v21, v18, v45
  v_perm_b32 v22, v143, v139, s65
  v_perm_b32 v11, v143, v139, s66
  v_dot2_f32_bf16 v46, v22, v18, v46
  v_dot2_f32_bf16 v47, v11, v18, v47
  v_perm_b32 v20, v148, v144, s65
  v_perm_b32 v21, v148, v144, s66
  v_dot2_f32_bf16 v40, v20, v19, v40
  v_dot2_f32_bf16 v41, v21, v19, v41
  v_perm_b32 v22, v149, v145, s65
  v_perm_b32 v11, v149, v145, s66
  v_dot2_f32_bf16 v42, v22, v19, v42
  v_dot2_f32_bf16 v43, v11, v19, v43
  v_perm_b32 v20, v150, v146, s65
  v_perm_b32 v21, v150, v146, s66
  v_dot2_f32_bf16 v44, v20, v19, v44
  v_dot2_f32_bf16 v45, v21, v19, v45
  v_perm_b32 v22, v151, v147, s65
  v_perm_b32 v11, v151, v147, s66
  v_dot2_f32_bf16 v46, v22, v19, v46
  v_dot2_f32_bf16 v47, v11, v19, v47
  s_cmp_eq_u32 s75, 0x40000000
  s_cbranch_scc1 L1_exit
  s_waitcnt lgkmcnt(0)
  v_readfirstlane_b32 s61, v23
  s_lshr_b32 s12, s61, 2
  s_lshl_b32 s13, s12, 2
  s_add_u32 s13, s13, s64
  s_sub_u32 s14, s12, s8
  s_add_u32 s14, s14, s9
  s_cmp_lt_u32 s12, s8
  s_cselect_b32 s13, s13, s14
  s_lshl_b32 s13, s13, 14
  s_and_b32 s12, s61, 3
  s_lshl_b32 s12, s12, 12
  s_add_u32 s13, s13, s12
  s_add_u32 s13, s13, s60
  s_cmp_lt_u32 s61, s10
  s_cselect_b32 s74, s13, 0x40000000
  s_mov_b64 exec, 1
  ds_add_rtn_u32 v23, v249, v250 offset:8328
  s_mov_b64 exec, -1
  buffer_load_dwordx4 v[120:123], v3, s[36:39], s74 offen offset:0 nt
  buffer_load_dwordx4 v[124:127], v3, s[36:39], s74 offen offset:64 nt
  buffer_load_dwordx4 v[128:131], v3, s[36:39], s74 offen offset:128 nt
  buffer_load_dwordx4 v[132:135], v3, s[36:39], s74 offen offset:192 nt
  buffer_load_dwordx4 v[136:139], v4, s[40:43], s74 offen offset:0 nt
  buffer_load_dwordx4 v[140:143], v4, s[40:43], s74 offen offset:256 nt
  buffer_load_dwordx4 v[144:147], v4, s[40:43], s74 offen offset:512 nt
  buffer_load_dwordx4 v[148:151], v4, s[40:43], s74 offen offset:768 nt
  s_add_u32 m0, s71, 69632
  s_add_u32 s61, s83, 33280
  buffer_load_dwordx4 v251, s[44:47], s61 offen lds
  s_add_u32 m0, s71, 70656
  s_add_u32 s61, s83, 41472
  buffer_load_dwordx4 v251, s[44:47], s61 offen lds
  s_waitcnt vmcnt(36)
  v_dot2_f32_bf16 v48, v152, v52, 0
  v_dot2_f32_bf16 v49, v156, v52, 0
  v_dot2_f32_bf16 v50, v160, v52, 0
  v_dot2_f32_bf16 v51, v164, v52, 0
  v_dot2_f32_bf16 v48, v153, v53, v48
  v_dot2_f32_bf16 v49, v157, v53, v49
  v_dot2_f32_bf16 v50, v161, v53, v50
  v_dot2_f32_bf16 v51, v165, v53, v51
  v_dot2_f32_bf16 v48, v154, v54, v48
  v_dot2_f32_bf16 v49, v158, v54, v49
  v_dot2_f32_bf16 v50, v162, v54, v50
  v_dot2_f32_bf16 v51, v166, v54, v51
  v_dot2_f32_bf16 v48, v155, v55, v48
  v_dot2_f32_bf16 v49, v159, v55, v49
  v_dot2_f32_bf16 v50, v163, v55, v50
  v_dot2_f32_bf16 v51, v167, v55, v51
  s_nop 0
  v_add_f32_dpp v48, v48, v48 row_ror:8 row_mask:0xf bank_mask:0xf
  v_add_f32_dpp v49, v49, v49 row_ror:8 row_mask:0xf bank_mask:0xf
  v_add_f32_dpp v50, v50, v50 row_ror:8 row_mask:0xf bank_mask:0xf
  v_add_f32_dpp v51, v51, v51 row_ror:8 row_mask:0xf bank_mask:0xf
  v_add_f32_dpp v48, v48, v48 row_ror:4 row_mask:0xf bank_mask:0xf
  v_add_f32_dpp v49, v49, v49 row_ror:4 row_mask:0xf bank_mask:0xf
  v_add_f32_dpp v50, v50, v50 row_ror:4 row_mask:0xf bank_mask:0xf
  v_add_f32_dpp v51, v51, v51 row_ror:4 row_mask:0xf bank_mask:0xf
  v_add_f32_dpp v48, v48, v48 row_ror:2 row_mask:0xf bank_mask:0xf
  v_add_f32_dpp v49, v49, v49 row_ror:2 row_mask:0xf bank_mask:0xf
  v_add_f32_dpp v50, v50, v50 row_ror:2 row_mask:0xf bank_mask:0xf
  v_add_f32_dpp v51, v51, v51 row_ror:2 row_mask:0xf bank_mask:0xf
  v_add_f32_dpp v48, v48, v48 row_ror:1 row_mask:0xf bank_mask:0xf
  v_add_f32_dpp v49, v49, v49 row_ror:1 row_mask:0xf bank_mask:0xf
  v_add_f32_dpp v50, v50, v50 row_ror:1 row_mask:0xf bank_mask:0xf
  v_add_f32_dpp v51, v51, v51 row_ror:1 row_mask:0xf bank_mask:0xf
  s_waitcnt vmcnt(32)
  v_cvt_pk_bf16_f32 v16, v48, v49
  v_lshlrev_b32 v48, 16, v16
  v_and_b32 v49, 0xffff0000, v16
  v_mul_f32 v48, s68, v48
  v_mul_f32 v49, s68, v49
  v_cvt_pk_bf16_f32 v16, v48, v49
  v_lshlrev_b32 v48, 16, v16
  v_and_b32 v49, 0xffff0000, v16
  v_cvt_pk_bf16_f32 v16, v50, v51
  v_lshlrev_b32 v50, 16, v16
  v_and_b32 v51, 0xffff0000, v16
  v_mul_f32 v50, s68, v50
  v_mul_f32 v51, s68, v51
  v_cvt_pk_bf16_f32 v16, v50, v51
  v_lshlrev_b32 v50, 16, v16
  v_and_b32 v51, 0xffff0000, v16
  v_max3_f32 v8, v48, v49, v5
  v_max3_f32 v8, v50, v51, v8
  v_sub_f32 v9, v5, v8
  v_mul_f32 v10, s67, v8
  v_mul_f32 v9, s67, v9
  v_fma_f32 v12, v48, s67, -v10
  v_fma_f32 v13, v49, s67, -v10
  v_fma_f32 v14, v50, s67, -v10
  v_fma_f32 v15, v51, s67, -v10
  v_exp_f32 v9, v9
  v_exp_f32 v12, v12
  v_exp_f32 v13, v13
  v_exp_f32 v14, v14
  v_exp_f32 v15, v15
  v_mov_b32 v5, v8
  v_mul_f32 v40, v9, v40
  v_mul_f32 v41, v9, v41
  v_mul_f32 v42, v9, v42
  v_mul_f32 v43, v9, v43
  v_mul_f32 v44, v9, v44
  v_mul_f32 v45, v9, v45
  v_mul_f32 v46, v9, v46
  v_mul_f32 v47, v9, v47
  v_cvt_pk_bf16_f32 v18, v12, v13
  v_cvt_pk_bf16_f32 v19, v14, v15
  v_add_f32 v16, v12, v13
  v_add_f32 v17, v14, v15
  v_add_f32 v16, v16, v17
  v_fma_f32 v6, v6, v9, v16
  v_perm_b32 v20, v172, v168, s65
  v_perm_b32 v21, v172, v168, s66
  v_dot2_f32_bf16 v40, v20, v18, v40
  v_dot2_f32_bf16 v41, v21, v18, v41
  v_perm_b32 v22, v173, v169, s65
  v_perm_b32 v11, v173, v169, s66
  v_dot2_f32_bf16 v42, v22, v18, v42
  v_dot2_f32_bf16 v43, v11, v18, v43
  v_perm_b32 v20, v174, v170, s65
  v_perm_b32 v21, v174, v170, s66
  v_dot2_f32_bf16 v44, v20, v18, v44
  v_dot2_f32_bf16 v45, v21, v18, v45
  v_perm_b32 v22, v175, v171, s65
  v_perm_b32 v11, v175, v171, s66
  v_dot2_f32_bf16 v46, v22, v18, v46
  v_dot2_f32_bf16 v47, v11, v18, v47
  v_perm_b32 v20, v180, v176, s65
  v_perm_b32 v21, v180, v176, s66
  v_dot2_f32_bf16 v40, v20, v19, v40
  v_dot2_f32_bf16 v41, v21, v19, v41
  v_perm_b32 v22, v181, v177, s65
  v_perm_b32 v11, v181, v177, s66
  v_dot2_f32_bf16 v42, v22, v19, v42
  v_dot2_f32_bf16 v43, v11, v19, v43
  v_perm_b32 v20, v182, v178, s65
  v_perm_b32 v21, v182, v178, s66
  v_dot2_f32_bf16 v44, v20, v19, v44
  v_dot2_f32_bf16 v45, v21, v19, v45
  v_perm_b32 v22, v183, v179, s65
  v_perm_b32 v11, v183, v179, s66
  v_dot2_f32_bf16 v46, v22, v19, v46
  v_dot2_f32_bf16 v47, v11, v19, v47
  s_cmp_eq_u32 s72, 0x40000000
  s_cbranch_scc1 L1_exit
  s_waitcnt lgkmcnt(0)
  v_readfirstlane_b32 s61, v23
  s_lshr_b32 s12, s61, 2
  s_lshl_b32 s13, s12, 2
  s_add_u32 s13, s13, s64
  s_sub_u32 s14, s12, s8
  s_add_u32 s14, s14, s9
  s_cmp_lt_u32 s12, s8
  s_cselect_b32 s13, s13, s14
  s_lshl_b32 s13, s13, 14
  s_and_b32 s12, s61, 3
  s_lshl_b32 s12, s12, 12
  s_add_u32 s13, s13, s12
  s_add_u32 s13, s13, s60
  s_cmp_lt_u32 s61, s10
  s_cselect_b32 s75, s13, 0x40000000
  s_mov_b64 exec, 1
  ds_add_rtn_u32 v23, v249, v250 offset:8328
  s_mov_b64 exec, -1
  buffer_load_dwordx4 v[152:155], v4, s[36:39], s75 offen offset:0 nt
  buffer_load_dwordx4 v[156:159], v4, s[36:39], s75 offen offset:256 nt
  buffer_load_dwordx4 v[160:163], v4, s[36:39], s75 offen offset:512 nt
  buffer_load_dwordx4 v[164:167], v4, s[36:39], s75 offen offset:768 nt
  buffer_load_dwordx4 v[168:171], v4, s[40:43], s75 offen offset:0 nt
  buffer_load_dwordx4 v[172:175], v4, s[40:43], s75 offen offset:256 nt
  buffer_load_dwordx4 v[176:179], v4, s[40:43], s75 offen offset:512 nt
  buffer_load_dwordx4 v[180:183], v4, s[40:43], s75 offen offset:768 nt
  s_add_u32 m0, s71, 71680
  s_add_u32 s61, s83, 49664
  buffer_load_dwordx4 v251, s[44:47], s61 offen lds
  s_add_u32 m0, s71, 72704
  s_add_u32 s61, s83, 57856
  buffer_load_dwordx4 v251, s[44:47], s61 offen lds
  s_waitcnt vmcnt(36)
  v_mfma_f32_16x16x32_bf16 v[48:51], v[56:59], v[24:27], 0
  v_mfma_f32_16x16x32_bf16 v[48:51], v[60:63], v[28:31], v[48:51]
  v_mfma_f32_16x16x32_bf16 v[48:51], v[64:67], v[32:35], v[48:51]
  v_mfma_f32_16x16x32_bf16 v[48:51], v[68:71], v[36:39], v[48:51]
  s_nop 7
  s_waitcnt vmcnt(32)
  v_cvt_pk_bf16_f32 v16, v48, v49
  v_lshlrev_b32 v48, 16, v16
  v_and_b32 v49, 0xffff0000, v16
  v_mul_f32 v48, s68, v48
  v_mul_f32 v49, s68, v49
  v_cvt_pk_bf16_f32 v16, v48, v49
  v_lshlrev_b32 v48, 16, v16
  v_and_b32 v49, 0xffff0000, v16
  v_cvt_pk_bf16_f32 v16, v50, v51
  v_lshlrev_b32 v50, 16, v16
  v_and_b32 v51, 0xffff0000, v16
  v_mul_f32 v50, s68, v50
  v_mul_f32 v51, s68, v51
  v_cvt_pk_bf16_f32 v16, v50, v51
  v_lshlrev_b32 v50, 16, v16
  v_and_b32 v51, 0xffff0000, v16
  v_max3_f32 v8, v48, v49, v5
  v_max3_f32 v8, v50, v51, v8
  v_sub_f32 v9, v5, v8
  v_mul_f32 v10, s67, v8
  v_mul_f32 v9, s67, v9
  v_fma_f32 v12, v48, s67, -v10
  v_fma_f32 v13, v49, s67, -v10
  v_fma_f32 v14, v50, s67, -v10
  v_fma_f32 v15, v51, s67, -v10
  v_exp_f32 v9, v9
  v_exp_f32 v12, v12
  v_exp_f32 v13, v13
  v_exp_f32 v14, v14
  v_exp_f32 v15, v15
  v_mov_b32 v5, v8
  v_mul_f32 v40, v9, v40
  v_mul_f32 v41, v9, v41
  v_mul_f32 v42, v9, v42
  v_mul_f32 v43, v9, v43
  v_mul_f32 v44, v9, v44
  v_mul_f32 v45, v9, v45
  v_mul_f32 v46, v9, v46
  v_mul_f32 v47, v9, v47
  v_cvt_pk_bf16_f32 v18, v12, v13
  v_cvt_pk_bf16_f32 v19, v14, v15
  v_add_f32 v16, v12, v13
  v_add_f32 v17, v14, v15
  v_add_f32 v16, v16, v17
  v_fma_f32 v6, v6, v9, v16
  v_perm_b32 v20, v76, v72, s65
  v_perm_b32 v21, v76, v72, s66
  v_dot2_f32_bf16 v40, v20, v18, v40
  v_dot2_f32_bf16 v41, v21, v18, v41
  v_perm_b32 v22, v77, v73, s65
  v_perm_b32 v11, v77, v73, s66
  v_dot2_f32_bf16 v42, v22, v18, v42
  v_dot2_f32_bf16 v43, v11, v18, v43
  v_perm_b32 v20, v78, v74, s65
  v_perm_b32 v21, v78, v74, s66
  v_dot2_f32_bf16 v44, v20, v18, v44
  v_dot2_f32_bf16 v45, v21, v18, v45
  v_perm_b32 v22, v79, v75, s65
  v_perm_b32 v11, v79, v75, s66
  v_dot2_f32_bf16 v46, v22, v18, v46
  v_dot2_f32_bf16 v47, v11, v18, v47
  v_perm_b32 v20, v84, v80, s65
  v_perm_b32 v21, v84, v80, s66
  v_dot2_f32_bf16 v40, v20, v19, v40
  v_dot2_f32_bf16 v41, v21, v19, v41
  v_perm_b32 v22, v85, v81, s65
  v_perm_b32 v11, v85, v81, s66
  v_dot2_f32_bf16 v42, v22, v19, v42
  v_dot2_f32_bf16 v43, v11, v19, v43
  v_perm_b32 v20, v86, v82, s65
  v_perm_b32 v21, v86, v82, s66
  v_dot2_f32_bf16 v44, v20, v19, v44
  v_dot2_f32_bf16 v45, v21, v19, v45
  v_perm_b32 v22, v87, v83, s65
  v_perm_b32 v11, v87, v83, s66
  v_dot2_f32_bf16 v46, v22, v19, v46
  v_dot2_f32_bf16 v47, v11, v19, v47
  s_cmp_eq_u32 s73, 0x40000000
  s_cbranch_scc1 L1_exit
  s_waitcnt lgkmcnt(0)
  v_readfirstlane_b32 s61, v23
  s_lshr_b32 s12, s61, 2
  s_lshl_b32 s13, s12, 2
  s_add_u32 s13, s13, s64
  s_sub_u32 s14, s12, s8
  s_add_u32 s14, s14, s9
  s_cmp_lt_u32 s12, s8
  s_cselect_b32 s13, s13, s14
  s_lshl_b32 s13, s13, 14
  s_and_b32 s12, s61, 3
  s_lshl_b32 s12, s12, 12
  s_add_u32 s13, s13, s12
  s_add_u32 s13, s13, s60
  s_cmp_lt_u32 s61, s10
  s_cselect_b32 s72, s13, 0x40000000
  s_mov_b64 exec, 1
  ds_add_rtn_u32 v23, v249, v250 offset:8328
  s_mov_b64 exec, -1
  buffer_load_dwordx4 v[56:59], v3, s[36:39], s72 offen offset:0 nt
  buffer_load_dwordx4 v[60:63], v3, s[36:39], s72 offen offset:64 nt
  buffer_load_dwordx4 v[64:67], v3, s[36:39], s72 offen offset:128 nt
  buffer_load_dwordx4 v[68:71], v3, s[36:39], s72 offen offset:192 nt
  buffer_load_dwordx4 v[72:75], v4, s[40:43], s72 offen offset:0 nt
  buffer_load_dwordx4 v[76:79], v4, s[40:43], s72 offen offset:256 nt
  buffer_load_dwordx4 v[80:83], v4, s[40:43], s72 offen offset:512 nt
  buffer_load_dwordx4 v[84:87], v4, s[40:43], s72 offen offset:768 nt
  s_add_u32 m0, s71, 73728
  s_add_u32 s61, s83, 66048
  buffer_load_dwordx4 v251, s[44:47], s61 offen lds
  s_add_u32 m0, s71, 74752
  s_add_u32 s61, s83, 74240
  buffer_load_dwordx4 v251, s[44:47], s61 offen lds
  s_waitcnt vmcnt(36)
  v_dot2_f32_bf16 v48, v88, v52, 0
  v_dot2_f32_bf16 v49, v92, v52, 0
  v_dot2_f32_bf16 v50, v96, v52, 0
  v_dot2_f32_bf16 v51, v100, v52, 0
  v_dot2_f32_bf16 v48, v89, v53, v48
  v_dot2_f32_bf16 v49, v93, v53, v49
  v_dot2_f32_bf16 v50, v97, v53, v50
  v_dot2_f32_bf16 v51, v101, v53, v51
  v_dot2_f32_bf16 v48, v90, v54, v48
  v_dot2_f32_bf16 v49, v94, v54, v49
  v_dot2_f32_bf16 v50, v98, v54, v50
  v_dot2_f32_bf16 v51, v102, v54, v51
  v_dot2_f32_bf16 v48, v91, v55, v48
  v_dot2_f32_bf16 v49, v95, v55, v49
  v_dot2_f32_bf16 v50, v99, v55, v50
  v_dot2_f32_bf16 v51, v103, v55, v51
  s_nop 0
  v_add_f32_dpp v48, v48, v48 row_ror:8 row_mask:0xf bank_mask:0xf
  v_add_f32_dpp v49, v49, v49 row_ror:8 row_mask:0xf bank_mask:0xf
  v_add_f32_dpp v50, v50, v50 row_ror:8 row_mask:0xf bank_mask:0xf
  v_add_f32_dpp v51, v51, v51 row_ror:8 row_mask:0xf bank_mask:0xf
  v_add_f32_dpp v48, v48, v48 row_ror:4 row_mask:0xf bank_mask:0xf
  v_add_f32_dpp v49, v49, v49 row_ror:4 row_mask:0xf bank_mask:0xf
  v_add_f32_dpp v50, v50, v50 row_ror:4 row_mask:0xf bank_mask:0xf
  v_add_f32_dpp v51, v51, v51 row_ror:4 row_mask:0xf bank_mask:0xf
  v_add_f32_dpp v48, v48, v48 row_ror:2 row_mask:0xf bank_mask:0xf
  v_add_f32_dpp v49, v49, v49 row_ror:2 row_mask:0xf bank_mask:0xf
  v_add_f32_dpp v50, v50, v50 row_ror:2 row_mask:0xf bank_mask:0xf
  v_add_f32_dpp v51, v51, v51 row_ror:2 row_mask:0xf bank_mask:0xf
  v_add_f32_dpp v48, v48, v48 row_ror:1 row_mask:0xf bank_mask:0xf
  v_add_f32_dpp v49, v49, v49 row_ror:1 row_mask:0xf bank_mask:0xf
  v_add_f32_dpp v50, v50, v50 row_ror:1 row_mask:0xf bank_mask:0xf
  v_add_f32_dpp v51, v51, v51 row_ror:1 row_mask:0xf bank_mask:0xf
  s_waitcnt vmcnt(32)
  v_cvt_pk_bf16_f32 v16, v48, v49
  v_lshlrev_b32 v48, 16, v16
  v_and_b32 v49, 0xffff0000, v16
  v_mul_f32 v48, s68, v48
  v_mul_f32 v49, s68, v49
  v_cvt_pk_bf16_f32 v16, v48, v49
  v_lshlrev_b32 v48, 16, v16
  v_and_b32 v49, 0xffff0000, v16
  v_cvt_pk_bf16_f32 v16, v50, v51
  v_lshlrev_b32 v50, 16, v16
  v_and_b32 v51, 0xffff0000, v16
  v_mul_f32 v50, s68, v50
  v_mul_f32 v51, s68, v51
  v_cvt_pk_bf16_f32 v16, v50, v51
  v_lshlrev_b32 v50, 16, v16
  v_and_b32 v51, 0xffff0000, v16
  v_max3_f32 v8, v48, v49, v5
  v_max3_f32 v8, v50, v51, v8
  v_sub_f32 v9, v5, v8
  v_mul_f32 v10, s67, v8
  v_mul_f32 v9, s67, v9
  v_fma_f32 v12, v48, s67, -v10
  v_fma_f32 v13, v49, s67, -v10
  v_fma_f32 v14, v50, s67, -v10
  v_fma_f32 v15, v51, s67, -v10
  v_exp_f32 v9, v9
  v_exp_f32 v12, v12
  v_exp_f32 v13, v13
  v_exp_f32 v14, v14
  v_exp_f32 v15, v15
  v_mov_b32 v5, v8
  v_mul_f32 v40, v9, v40
  v_mul_f32 v41, v9, v41
  v_mul_f32 v42, v9, v42
  v_mul_f32 v43, v9, v43
  v_mul_f32 v44, v9, v44
  v_mul_f32 v45, v9, v45
  v_mul_f32 v46, v9, v46
  v_mul_f32 v47, v9, v47
  v_cvt_pk_bf16_f32 v18, v12, v13
  v_cvt_pk_bf16_f32 v19, v14, v15
  v_add_f32 v16, v12, v13
  v_add_f32 v17, v14, v15
  v_add_f32 v16, v16, v17
  v_fma_f32 v6, v6, v9, v16
  v_perm_b32 v20, v108, v104, s65
  v_perm_b32 v21, v108, v104, s66
  v_dot2_f32_bf16 v40, v20, v18, v40
  v_dot2_f32_bf16 v41, v21, v18, v41
  v_perm_b32 v22, v109, v105, s65
  v_perm_b32 v11, v109, v105, s66
  v_dot2_f32_bf16 v42, v22, v18, v42
  v_dot2_f32_bf16 v43, v11, v18, v43
  v_perm_b32 v20, v110, v106, s65
  v_perm_b32 v21, v110, v106, s66
  v_dot2_f32_bf16 v44, v20, v18, v44
  v_dot2_f32_bf16 v45, v21, v18, v45
  v_perm_b32 v22, v111, v107, s65
  v_perm_b32 v11, v111, v107, s66
  v_dot2_f32_bf16 v46, v22, v18, v46
  v_dot2_f32_bf16 v47, v11, v18, v47
  v_perm_b32 v20, v116, v112, s65
  v_perm_b32 v21, v116, v112, s66
  v_dot2_f32_bf16 v40, v20, v19, v40
  v_dot2_f32_bf16 v41, v21, v19, v41
  v_perm_b32 v22, v117, v113, s65
  v_perm_b32 v11, v117, v113, s66
  v_dot2_f32_bf16 v42, v22, v19, v42
  v_dot2_f32_bf16 v43, v11, v19, v43
  v_perm_b32 v20, v118, v114, s65
  v_perm_b32 v21, v118, v114, s66
  v_dot2_f32_bf16 v44, v20, v19, v44
  v_dot2_f32_bf16 v45, v21, v19, v45
  v_perm_b32 v22, v119, v115, s65
  v_perm_b32 v11, v119, v115, s66
  v_dot2_f32_bf16 v46, v22, v19, v46
  v_dot2_f32_bf16 v47, v11, v19, v47
  s_cmp_eq_u32 s74, 0x40000000
  s_cbranch_scc1 L1_exit
  s_waitcnt lgkmcnt(0)
  v_readfirstlane_b32 s61, v23
  s_lshr_b32 s12, s61, 2
  s_lshl_b32 s13, s12, 2
  s_add_u32 s13, s13, s64
  s_sub_u32 s14, s12, s8
  s_add_u32 s14, s14, s9
  s_cmp_lt_u32 s12, s8
  s_cselect_b32 s13, s13, s14
  s_lshl_b32 s13, s13, 14
  s_and_b32 s12, s61, 3
  s_lshl_b32 s12, s12, 12
  s_add_u32 s13, s13, s12
  s_add_u32 s13, s13, s60
  s_cmp_lt_u32 s61, s10
  s_cselect_b32 s73, s13, 0x40000000
  s_mov_b64 exec, 1
  ds_add_rtn_u32 v23, v249, v250 offset:8328
  s_mov_b64 exec, -1
  buffer_load_dwordx4 v[88:91], v4, s[36:39], s73 offen offset:0 nt
  buffer_load_dwordx4 v[92:95], v4, s[36:39], s73 offen offset:256 nt
  buffer_load_dwordx4 v[96:99], v4, s[36:39], s73 offen offset:512 nt
  buffer_load_dwordx4 v[100:103], v4, s[36:39], s73 offen offset:768 nt
  buffer_load_dwordx4 v[104:107], v4, s[40:43], s73 offen offset:0 nt
  buffer_load_dwordx4 v[108:111], v4, s[40:43], s73 offen offset:256 nt
  buffer_load_dwordx4 v[112:115], v4, s[40:43], s73 offen offset:512 nt
  buffer_load_dwordx4 v[116:119], v4, s[40:43], s73 offen offset:768 nt
  s_add_u32 m0, s71, 75776
  s_add_u32 s61, s83, 82432
  buffer_load_dwordx4 v251, s[44:47], s61 offen lds
  s_add_u32 m0, s71, 76800
  s_add_u32 s61, s83, 90624
  buffer_load_dwordx4 v251, s[44:47], s61 offen lds
  s_waitcnt vmcnt(36)
  v_mfma_f32_16x16x32_bf16 v[48:51], v[120:123], v[24:27], 0
  v_mfma_f32_16x16x32_bf16 v[48:51], v[124:127], v[28:31], v[48:51]
  v_mfma_f32_16x16x32_bf16 v[48:51], v[128:131], v[32:35], v[48:51]
  v_mfma_f32_16x16x32_bf16 v[48:51], v[132:135], v[36:39], v[48:51]
  s_nop 7
  s_waitcnt vmcnt(32)
  v_cvt_pk_bf16_f32 v16, v48, v49
  v_lshlrev_b32 v48, 16, v16
  v_and_b32 v49, 0xffff0000, v16
  v_mul_f32 v48, s68, v48
  v_mul_f32 v49, s68, v49
  v_cvt_pk_bf16_f32 v16, v48, v49
  v_lshlrev_b32 v48, 16, v16
  v_and_b32 v49, 0xffff0000, v16
  v_cvt_pk_bf16_f32 v16, v50, v51
  v_lshlrev_b32 v50, 16, v16
  v_and_b32 v51, 0xffff0000, v16
  v_mul_f32 v50, s68, v50
  v_mul_f32 v51, s68, v51
  v_cvt_pk_bf16_f32 v16, v50, v51
  v_lshlrev_b32 v50, 16, v16
  v_and_b32 v51, 0xffff0000, v16
  v_max3_f32 v8, v48, v49, v5
  v_max3_f32 v8, v50, v51, v8
  v_sub_f32 v9, v5, v8
  v_mul_f32 v10, s67, v8
  v_mul_f32 v9, s67, v9
  v_fma_f32 v12, v48, s67, -v10
  v_fma_f32 v13, v49, s67, -v10
  v_fma_f32 v14, v50, s67, -v10
  v_fma_f32 v15, v51, s67, -v10
  v_exp_f32 v9, v9
  v_exp_f32 v12, v12
  v_exp_f32 v13, v13
  v_exp_f32 v14, v14
  v_exp_f32 v15, v15
  v_mov_b32 v5, v8
  v_mul_f32 v40, v9, v40
  v_mul_f32 v41, v9, v41
  v_mul_f32 v42, v9, v42
  v_mul_f32 v43, v9, v43
  v_mul_f32 v44, v9, v44
  v_mul_f32 v45, v9, v45
  v_mul_f32 v46, v9, v46
  v_mul_f32 v47, v9, v47
  v_cvt_pk_bf16_f32 v18, v12, v13
  v_cvt_pk_bf16_f32 v19, v14, v15
  v_add_f32 v16, v12, v13
  v_add_f32 v17, v14, v15
  v_add_f32 v16, v16, v17
  v_fma_f32 v6, v6, v9, v16
  v_perm_b32 v20, v140, v136, s65
  v_perm_b32 v21, v140, v136, s66
  v_dot2_f32_bf16 v40, v20, v18, v40
  v_dot2_f32_bf16 v41, v21, v18, v41
  v_perm_b32 v22, v141, v137, s65
  v_perm_b32 v11, v141, v137, s66
  v_dot2_f32_bf16 v42, v22, v18, v42
  v_dot2_f32_bf16 v43, v11, v18, v43
  v_perm_b32 v20, v142, v138, s65
  v_perm_b32 v21, v142, v138, s66
  v_dot2_f32_bf16 v44, v20, v18, v44
  v_dot2_f32_bf16 v45, v21, v18, v45
  v_perm_b32 v22, v143, v139, s65
  v_perm_b32 v11, v143, v139, s66
  v_dot2_f32_bf16 v46, v22, v18, v46
  v_dot2_f32_bf16 v47, v11, v18, v47
  v_perm_b32 v20, v148, v144, s65
  v_perm_b32 v21, v148, v144, s66
  v_dot2_f32_bf16 v40, v20, v19, v40
  v_dot2_f32_bf16 v41, v21, v19, v41
  v_perm_b32 v22, v149, v145, s65
  v_perm_b32 v11, v149, v145, s66
  v_dot2_f32_bf16 v42, v22, v19, v42
  v_dot2_f32_bf16 v43, v11, v19, v43
  v_perm_b32 v20, v150, v146, s65
  v_perm_b32 v21, v150, v146, s66
  v_dot2_f32_bf16 v44, v20, v19, v44
  v_dot2_f32_bf16 v45, v21, v19, v45
  v_perm_b32 v22, v151, v147, s65
  v_perm_b32 v11, v151, v147, s66
  v_dot2_f32_bf16 v46, v22, v19, v46
  v_dot2_f32_bf16 v47, v11, v19, v47
  s_cmp_eq_u32 s75, 0x40000000
  s_cbranch_scc1 L1_exit
  s_waitcnt lgkmcnt(0)
  v_readfirstlane_b32 s61, v23
  s_lshr_b32 s12, s61, 2
  s_lshl_b32 s13, s12, 2
  s_add_u32 s13, s13, s64
  s_sub_u32 s14, s12, s8
  s_add_u32 s14, s14, s9
  s_cmp_lt_u32 s12, s8
  s_cselect_b32 s13, s13, s14
  s_lshl_b32 s13, s13, 14
  s_and_b32 s12, s61, 3
  s_lshl_b32 s12, s12, 12
  s_add_u32 s13, s13, s12
  s_add_u32 s13, s13, s60
  s_cmp_lt_u32 s61, s10
  s_cselect_b32 s74, s13, 0x40000000
  s_mov_b64 exec, 1
  ds_add_rtn_u32 v23, v249, v250 offset:8328
  s_mov_b64 exec, -1
  buffer_load_dwordx4 v[120:123], v3, s[36:39], s74 offen offset:0 nt
  buffer_load_dwordx4 v[124:127], v3, s[36:39], s74 offen offset:64 nt
  buffer_load_dwordx4 v[128:131], v3, s[36:39], s74 offen offset:128 nt
  buffer_load_dwordx4 v[132:135], v3, s[36:39], s74 offen offset:192 nt
  buffer_load_dwordx4 v[136:139], v4, s[40:43], s74 offen offset:0 nt
  buffer_load_dwordx4 v[140:143], v4, s[40:43], s74 offen offset:256 nt
  buffer_load_dwordx4 v[144:147], v4, s[40:43], s74 offen offset:512 nt
  buffer_load_dwordx4 v[148:151], v4, s[40:43], s74 offen offset:768 nt
  s_add_u32 m0, s71, 77824
  s_add_u32 s61, s83, 98816
  buffer_load_dwordx4 v251, s[44:47], s61 offen lds
  s_add_u32 m0, s71, 78848
  s_add_u32 s61, s83, 107008
  buffer_load_dwordx4 v251, s[44:47], s61 offen lds
  s_waitcnt vmcnt(36)
  v_dot2_f32_bf16 v48, v152, v52, 0
  v_dot2_f32_bf16 v49, v156, v52, 0
  v_dot2_f32_bf16 v50, v160, v52, 0
  v_dot2_f32_bf16 v51, v164, v52, 0
  v_dot2_f32_bf16 v48, v153, v53, v48
  v_dot2_f32_bf16 v49, v157, v53, v49
  v_dot2_f32_bf16 v50, v161, v53, v50
  v_dot2_f32_bf16 v51, v165, v53, v51
  v_dot2_f32_bf16 v48, v154, v54, v48
  v_dot2_f32_bf16 v49, v158, v54, v49
  v_dot2_f32_bf16 v50, v162, v54, v50
  v_dot2_f32_bf16 v51, v166, v54, v51
  v_dot2_f32_bf16 v48, v155, v55, v48
  v_dot2_f32_bf16 v49, v159, v55, v49
  v_dot2_f32_bf16 v50, v163, v55, v50
  v_dot2_f32_bf16 v51, v167, v55, v51
  s_nop 0
  v_add_f32_dpp v48, v48, v48 row_ror:8 row_mask:0xf bank_mask:0xf
  v_add_f32_dpp v49, v49, v49 row_ror:8 row_mask:0xf bank_mask:0xf
  v_add_f32_dpp v50, v50, v50 row_ror:8 row_mask:0xf bank_mask:0xf
  v_add_f32_dpp v51, v51, v51 row_ror:8 row_mask:0xf bank_mask:0xf
  v_add_f32_dpp v48, v48, v48 row_ror:4 row_mask:0xf bank_mask:0xf
  v_add_f32_dpp v49, v49, v49 row_ror:4 row_mask:0xf bank_mask:0xf
  v_add_f32_dpp v50, v50, v50 row_ror:4 row_mask:0xf bank_mask:0xf
  v_add_f32_dpp v51, v51, v51 row_ror:4 row_mask:0xf bank_mask:0xf
  v_add_f32_dpp v48, v48, v48 row_ror:2 row_mask:0xf bank_mask:0xf
  v_add_f32_dpp v49, v49, v49 row_ror:2 row_mask:0xf bank_mask:0xf
  v_add_f32_dpp v50, v50, v50 row_ror:2 row_mask:0xf bank_mask:0xf
  v_add_f32_dpp v51, v51, v51 row_ror:2 row_mask:0xf bank_mask:0xf
  v_add_f32_dpp v48, v48, v48 row_ror:1 row_mask:0xf bank_mask:0xf
  v_add_f32_dpp v49, v49, v49 row_ror:1 row_mask:0xf bank_mask:0xf
  v_add_f32_dpp v50, v50, v50 row_ror:1 row_mask:0xf bank_mask:0xf
  v_add_f32_dpp v51, v51, v51 row_ror:1 row_mask:0xf bank_mask:0xf
  s_waitcnt vmcnt(32)
  v_cvt_pk_bf16_f32 v16, v48, v49
  v_lshlrev_b32 v48, 16, v16
  v_and_b32 v49, 0xffff0000, v16
  v_mul_f32 v48, s68, v48
  v_mul_f32 v49, s68, v49
  v_cvt_pk_bf16_f32 v16, v48, v49
  v_lshlrev_b32 v48, 16, v16
  v_and_b32 v49, 0xffff0000, v16
  v_cvt_pk_bf16_f32 v16, v50, v51
  v_lshlrev_b32 v50, 16, v16
  v_and_b32 v51, 0xffff0000, v16
  v_mul_f32 v50, s68, v50
  v_mul_f32 v51, s68, v51
  v_cvt_pk_bf16_f32 v16, v50, v51
  v_lshlrev_b32 v50, 16, v16
  v_and_b32 v51, 0xffff0000, v16
  v_max3_f32 v8, v48, v49, v5
  v_max3_f32 v8, v50, v51, v8
  v_sub_f32 v9, v5, v8
  v_mul_f32 v10, s67, v8
  v_mul_f32 v9, s67, v9
  v_fma_f32 v12, v48, s67, -v10
  v_fma_f32 v13, v49, s67, -v10
  v_fma_f32 v14, v50, s67, -v10
  v_fma_f32 v15, v51, s67, -v10
  v_exp_f32 v9, v9
  v_exp_f32 v12, v12
  v_exp_f32 v13, v13
  v_exp_f32 v14, v14
  v_exp_f32 v15, v15
  v_mov_b32 v5, v8
  v_mul_f32 v40, v9, v40
  v_mul_f32 v41, v9, v41
  v_mul_f32 v42, v9, v42
  v_mul_f32 v43, v9, v43
  v_mul_f32 v44, v9, v44
  v_mul_f32 v45, v9, v45
  v_mul_f32 v46, v9, v46
  v_mul_f32 v47, v9, v47
  v_cvt_pk_bf16_f32 v18, v12, v13
  v_cvt_pk_bf16_f32 v19, v14, v15
  v_add_f32 v16, v12, v13
  v_add_f32 v17, v14, v15
  v_add_f32 v16, v16, v17
  v_fma_f32 v6, v6, v9, v16
  v_perm_b32 v20, v172, v168, s65
  v_perm_b32 v21, v172, v168, s66
  v_dot2_f32_bf16 v40, v20, v18, v40
  v_dot2_f32_bf16 v41, v21, v18, v41
  v_perm_b32 v22, v173, v169, s65
  v_perm_b32 v11, v173, v169, s66
  v_dot2_f32_bf16 v42, v22, v18, v42
  v_dot2_f32_bf16 v43, v11, v18, v43
  v_perm_b32 v20, v174, v170, s65
  v_perm_b32 v21, v174, v170, s66
  v_dot2_f32_bf16 v44, v20, v18, v44
  v_dot2_f32_bf16 v45, v21, v18, v45
  v_perm_b32 v22, v175, v171, s65
  v_perm_b32 v11, v175, v171, s66
  v_dot2_f32_bf16 v46, v22, v18, v46
  v_dot2_f32_bf16 v47, v11, v18, v47
  v_perm_b32 v20, v180, v176, s65
  v_perm_b32 v21, v180, v176, s66
  v_dot2_f32_bf16 v40, v20, v19, v40
  v_dot2_f32_bf16 v41, v21, v19, v41
  v_perm_b32 v22, v181, v177, s65
  v_perm_b32 v11, v181, v177, s66
  v_dot2_f32_bf16 v42, v22, v19, v42
  v_dot2_f32_bf16 v43, v11, v19, v43
  v_perm_b32 v20, v182, v178, s65
  v_perm_b32 v21, v182, v178, s66
  v_dot2_f32_bf16 v44, v20, v19, v44
  v_dot2_f32_bf16 v45, v21, v19, v45
  v_perm_b32 v22, v183, v179, s65
  v_perm_b32 v11, v183, v179, s66
  v_dot2_f32_bf16 v46, v22, v19, v46
  v_dot2_f32_bf16 v47, v11, v19, v47
  s_cmp_eq_u32 s72, 0x40000000
  s_cbranch_scc1 L1_exit
  s_waitcnt lgkmcnt(0)
  v_readfirstlane_b32 s61, v23
  s_lshr_b32 s12, s61, 2
  s_lshl_b32 s13, s12, 2
  s_add_u32 s13, s13, s64
  s_sub_u32 s14, s12, s8
  s_add_u32 s14, s14, s9
  s_cmp_lt_u32 s12, s8
  s_cselect_b32 s13, s13, s14
  s_lshl_b32 s13, s13, 14
  s_and_b32 s12, s61, 3
  s_lshl_b32 s12, s12, 12
  s_add_u32 s13, s13, s12
  s_add_u32 s13, s13, s60
  s_cmp_lt_u32 s61, s10
  s_cselect_b32 s75, s13, 0x40000000
  s_mov_b64 exec, 1
  ds_add_rtn_u32 v23, v249, v250 offset:8328
  s_mov_b64 exec, -1
  buffer_load_dwordx4 v[152:155], v4, s[36:39], s75 offen offset:0 nt
  buffer_load_dwordx4 v[156:159], v4, s[36:39], s75 offen offset:256 nt
  buffer_load_dwordx4 v[160:163], v4, s[36:39], s75 offen offset:512 nt
  buffer_load_dwordx4 v[164:167], v4, s[36:39], s75 offen offset:768 nt
  buffer_load_dwordx4 v[168:171], v4, s[40:43], s75 offen offset:0 nt
  buffer_load_dwordx4 v[172:175], v4, s[40:43], s75 offen offset:256 nt
  buffer_load_dwordx4 v[176:179], v4, s[40:43], s75 offen offset:512 nt
  buffer_load_dwordx4 v[180:183], v4, s[40:43], s75 offen offset:768 nt
  s_add_u32 m0, s71, 79872
  s_add_u32 s61, s83, 115200
  buffer_load_dwordx4 v251, s[44:47], s61 offen lds
  s_add_u32 m0, s71, 80896
  s_add_u32 s61, s83, 123392
  buffer_load_dwordx4 v251, s[44:47], s61 offen lds
  s_mov_b32 s82, 1
L1_body:
  s_waitcnt vmcnt(28)
  v_mfma_f32_16x16x32_bf16 v[48:51], v[56:59], v[24:27], 0
  v_mfma_f32_16x16x32_bf16 v[48:51], v[60:63], v[28:31], v[48:51]
  v_mfma_f32_16x16x32_bf16 v[48:51], v[64:67], v[32:35], v[48:51]
  v_mfma_f32_16x16x32_bf16 v[48:51], v[68:71], v[36:39], v[48:51]
  s_nop 7
  s_waitcnt vmcnt(24)
  v_cvt_pk_bf16_f32 v16, v48, v49
  v_lshlrev_b32 v48, 16, v16
  v_and_b32 v49, 0xffff0000, v16
  v_mul_f32 v48, s68, v48
  v_mul_f32 v49, s68, v49
  v_cvt_pk_bf16_f32 v16, v48, v49
  v_lshlrev_b32 v48, 16, v16
  v_and_b32 v49, 0xffff0000, v16
  v_cvt_pk_bf16_f32 v16, v50, v51
  v_lshlrev_b32 v50, 16, v16
  v_and_b32 v51, 0xffff0000, v16
  v_mul_f32 v50, s68, v50
  v_mul_f32 v51, s68, v51
  v_cvt_pk_bf16_f32 v16, v50, v51
  v_lshlrev_b32 v50, 16, v16
  v_and_b32 v51, 0xffff0000, v16
  v_max3_f32 v8, v48, v49, v5
  v_max3_f32 v8, v50, v51, v8
  v_sub_f32 v9, v5, v8
  v_mul_f32 v10, s67, v8
  v_mul_f32 v9, s67, v9
  v_fma_f32 v12, v48, s67, -v10
  v_fma_f32 v13, v49, s67, -v10
  v_fma_f32 v14, v50, s67, -v10
  v_fma_f32 v15, v51, s67, -v10
  v_exp_f32 v9, v9
  v_exp_f32 v12, v12
  v_exp_f32 v13, v13
  v_exp_f32 v14, v14
  v_exp_f32 v15, v15
  v_mov_b32 v5, v8
  v_mul_f32 v40, v9, v40
  v_mul_f32 v41, v9, v41
  v_mul_f32 v42, v9, v42
  v_mul_f32 v43, v9, v43
  v_mul_f32 v44, v9, v44
  v_mul_f32 v45, v9, v45
  v_mul_f32 v46, v9, v46
  v_mul_f32 v47, v9, v47
  v_cvt_pk_bf16_f32 v18, v12, v13
  v_cvt_pk_bf16_f32 v19, v14, v15
  v_add_f32 v16, v12, v13
  v_add_f32 v17, v14, v15
  v_add_f32 v16, v16, v17
  v_fma_f32 v6, v6, v9, v16
  v_perm_b32 v20, v76, v72, s65
  v_perm_b32 v21, v76, v72, s66
  v_dot2_f32_bf16 v40, v20, v18, v40
  v_dot2_f32_bf16 v41, v21, v18, v41
  v_perm_b32 v22, v77, v73, s65
  v_perm_b32 v11, v77, v73, s66
  v_dot2_f32_bf16 v42, v22, v18, v42
  v_dot2_f32_bf16 v43, v11, v18, v43
  v_perm_b32 v20, v78, v74, s65
  v_perm_b32 v21, v78, v74, s66
  v_dot2_f32_bf16 v44, v20, v18, v44
  v_dot2_f32_bf16 v45, v21, v18, v45
  v_perm_b32 v22, v79, v75, s65
  v_perm_b32 v11, v79, v75, s66
  v_dot2_f32_bf16 v46, v22, v18, v46
  v_dot2_f32_bf16 v47, v11, v18, v47
  v_perm_b32 v20, v84, v80, s65
  v_perm_b32 v21, v84, v80, s66
  v_dot2_f32_bf16 v40, v20, v19, v40
  v_dot2_f32_bf16 v41, v21, v19, v41
  v_perm_b32 v22, v85, v81, s65
  v_perm_b32 v11, v85, v81, s66
  v_dot2_f32_bf16 v42, v22, v19, v42
  v_dot2_f32_bf16 v43, v11, v19, v43
  v_perm_b32 v20, v86, v82, s65
  v_perm_b32 v21, v86, v82, s66
  v_dot2_f32_bf16 v44, v20, v19, v44
  v_dot2_f32_bf16 v45, v21, v19, v45
  v_perm_b32 v22, v87, v83, s65
  v_perm_b32 v11, v87, v83, s66
  v_dot2_f32_bf16 v46, v22, v19, v46
  v_dot2_f32_bf16 v47, v11, v19, v47
  s_cmp_eq_u32 s73, 0x40000000
  s_cbranch_scc1 L1_exit
  s_waitcnt lgkmcnt(0)
  v_readfirstlane_b32 s61, v23
  s_lshr_b32 s12, s61, 2
  s_lshl_b32 s13, s12, 2
  s_add_u32 s13, s13, s64
  s_sub_u32 s14, s12, s8
  s_add_u32 s14, s14, s9
  s_cmp_lt_u32 s12, s8
  s_cselect_b32 s13, s13, s14
  s_lshl_b32 s13, s13, 14
  s_and_b32 s12, s61, 3
  s_lshl_b32 s12, s12, 12
  s_add_u32 s13, s13, s12
  s_add_u32 s13, s13, s60
  s_cmp_lt_u32 s61, s10
  s_cselect_b32 s72, s13, 0x40000000
  s_mov_b64 exec, 1
  ds_add_rtn_u32 v23, v249, v250 offset:8328
  s_mov_b64 exec, -1
  buffer_load_dwordx4 v[56:59], v3, s[36:39], s72 offen offset:0 nt
  buffer_load_dwordx4 v[60:63], v3, s[36:39], s72 offen offset:64 nt
  buffer_load_dwordx4 v[64:67], v3, s[36:39], s72 offen offset:128 nt
  buffer_load_dwordx4 v[68:71], v3, s[36:39], s72 offen offset:192 nt
  buffer_load_dwordx4 v[72:75], v4, s[40:43], s72 offen offset:0 nt
  buffer_load_dwordx4 v[76:79], v4, s[40:43], s72 offen offset:256 nt
  buffer_load_dwordx4 v[80:83], v4, s[40:43], s72 offen offset:512 nt
  buffer_load_dwordx4 v[84:87], v4, s[40:43], s72 offen offset:768 nt
  s_waitcnt vmcnt(28)
  v_dot2_f32_bf16 v48, v88, v52, 0
  v_dot2_f32_bf16 v49, v92, v52, 0
  v_dot2_f32_bf16 v50, v96, v52, 0
  v_dot2_f32_bf16 v51, v100, v52, 0
  v_dot2_f32_bf16 v48, v89, v53, v48
  v_dot2_f32_bf16 v49, v93, v53, v49
  v_dot2_f32_bf16 v50, v97, v53, v50
  v_dot2_f32_bf16 v51, v101, v53, v51
  v_dot2_f32_bf16 v48, v90, v54, v48
  v_dot2_f32_bf16 v49, v94, v54, v49
  v_dot2_f32_bf16 v50, v98, v54, v50
  v_dot2_f32_bf16 v51, v102, v54, v51
  v_dot2_f32_bf16 v48, v91, v55, v48
  v_dot2_f32_bf16 v49, v95, v55, v49
  v_dot2_f32_bf16 v50, v99, v55, v50
  v_dot2_f32_bf16 v51, v103, v55, v51
  s_nop 0
  v_add_f32_dpp v48, v48, v48 row_ror:8 row_mask:0xf bank_mask:0xf
  v_add_f32_dpp v49, v49, v49 row_ror:8 row_mask:0xf bank_mask:0xf
  v_add_f32_dpp v50, v50, v50 row_ror:8 row_mask:0xf bank_mask:0xf
  v_add_f32_dpp v51, v51, v51 row_ror:8 row_mask:0xf bank_mask:0xf
  v_add_f32_dpp v48, v48, v48 row_ror:4 row_mask:0xf bank_mask:0xf
  v_add_f32_dpp v49, v49, v49 row_ror:4 row_mask:0xf bank_mask:0xf
  v_add_f32_dpp v50, v50, v50 row_ror:4 row_mask:0xf bank_mask:0xf
  v_add_f32_dpp v51, v51, v51 row_ror:4 row_mask:0xf bank_mask:0xf
  v_add_f32_dpp v48, v48, v48 row_ror:2 row_mask:0xf bank_mask:0xf
  v_add_f32_dpp v49, v49, v49 row_ror:2 row_mask:0xf bank_mask:0xf
  v_add_f32_dpp v50, v50, v50 row_ror:2 row_mask:0xf bank_mask:0xf
  v_add_f32_dpp v51, v51, v51 row_ror:2 row_mask:0xf bank_mask:0xf
  v_add_f32_dpp v48, v48, v48 row_ror:1 row_mask:0xf bank_mask:0xf
  v_add_f32_dpp v49, v49, v49 row_ror:1 row_mask:0xf bank_mask:0xf
  v_add_f32_dpp v50, v50, v50 row_ror:1 row_mask:0xf bank_mask:0xf
  v_add_f32_dpp v51, v51, v51 row_ror:1 row_mask:0xf bank_mask:0xf
  s_waitcnt vmcnt(24)
  v_cvt_pk_bf16_f32 v16, v48, v49
  v_lshlrev_b32 v48, 16, v16
  v_and_b32 v49, 0xffff0000, v16
  v_mul_f32 v48, s68, v48
  v_mul_f32 v49, s68, v49
  v_cvt_pk_bf16_f32 v16, v48, v49
  v_lshlrev_b32 v48, 16, v16
  v_and_b32 v49, 0xffff0000, v16
  v_cvt_pk_bf16_f32 v16, v50, v51
  v_lshlrev_b32 v50, 16, v16
  v_and_b32 v51, 0xffff0000, v16
  v_mul_f32 v50, s68, v50
  v_mul_f32 v51, s68, v51
  v_cvt_pk_bf16_f32 v16, v50, v51
  v_lshlrev_b32 v50, 16, v16
  v_and_b32 v51, 0xffff0000, v16
  v_max3_f32 v8, v48, v49, v5
  v_max3_f32 v8, v50, v51, v8
  v_sub_f32 v9, v5, v8
  v_mul_f32 v10, s67, v8
  v_mul_f32 v9, s67, v9
  v_fma_f32 v12, v48, s67, -v10
  v_fma_f32 v13, v49, s67, -v10
  v_fma_f32 v14, v50, s67, -v10
  v_fma_f32 v15, v51, s67, -v10
  v_exp_f32 v9, v9
  v_exp_f32 v12, v12
  v_exp_f32 v13, v13
  v_exp_f32 v14, v14
  v_exp_f32 v15, v15
  v_mov_b32 v5, v8
  v_mul_f32 v40, v9, v40
  v_mul_f32 v41, v9, v41
  v_mul_f32 v42, v9, v42
  v_mul_f32 v43, v9, v43
  v_mul_f32 v44, v9, v44
  v_mul_f32 v45, v9, v45
  v_mul_f32 v46, v9, v46
  v_mul_f32 v47, v9, v47
  v_cvt_pk_bf16_f32 v18, v12, v13
  v_cvt_pk_bf16_f32 v19, v14, v15
  v_add_f32 v16, v12, v13
  v_add_f32 v17, v14, v15
  v_add_f32 v16, v16, v17
  v_fma_f32 v6, v6, v9, v16
  v_perm_b32 v20, v108, v104, s65
  v_perm_b32 v21, v108, v104, s66
  v_dot2_f32_bf16 v40, v20, v18, v40
  v_dot2_f32_bf16 v41, v21, v18, v41
  v_perm_b32 v22, v109, v105, s65
  v_perm_b32 v11, v109, v105, s66
  v_dot2_f32_bf16 v42, v22, v18, v42
  v_dot2_f32_bf16 v43, v11, v18, v43
  v_perm_b32 v20, v110, v106, s65
  v_perm_b32 v21, v110, v106, s66
  v_dot2_f32_bf16 v44, v20, v18, v44
  v_dot2_f32_bf16 v45, v21, v18, v45
  v_perm_b32 v22, v111, v107, s65
  v_perm_b32 v11, v111, v107, s66
  v_dot2_f32_bf16 v46, v22, v18, v46
  v_dot2_f32_bf16 v47, v11, v18, v47
  v_perm_b32 v20, v116, v112, s65
  v_perm_b32 v21, v116, v112, s66
  v_dot2_f32_bf16 v40, v20, v19, v40
  v_dot2_f32_bf16 v41, v21, v19, v41
  v_perm_b32 v22, v117, v113, s65
  v_perm_b32 v11, v117, v113, s66
  v_dot2_f32_bf16 v42, v22, v19, v42
  v_dot2_f32_bf16 v43, v11, v19, v43
  v_perm_b32 v20, v118, v114, s65
  v_perm_b32 v21, v118, v114, s66
  v_dot2_f32_bf16 v44, v20, v19, v44
  v_dot2_f32_bf16 v45, v21, v19, v45
  v_perm_b32 v22, v119, v115, s65
  v_perm_b32 v11, v119, v115, s66
  v_dot2_f32_bf16 v46, v22, v19, v46
  v_dot2_f32_bf16 v47, v11, v19, v47
  s_cmp_eq_u32 s74, 0x40000000
  s_cbranch_scc1 L1_exit
  s_waitcnt lgkmcnt(0)
  v_readfirstlane_b32 s61, v23
  s_lshr_b32 s12, s61, 2
  s_lshl_b32 s13, s12, 2
  s_add_u32 s13, s13, s64
  s_sub_u32 s14, s12, s8
  s_add_u32 s14, s14, s9
  s_cmp_lt_u32 s12, s8
  s_cselect_b32 s13, s13, s14
  s_lshl_b32 s13, s13, 14
  s_and_b32 s12, s61, 3
  s_lshl_b32 s12, s12, 12
  s_add_u32 s13, s13, s12
  s_add_u32 s13, s13, s60
  s_cmp_lt_u32 s61, s10
  s_cselect_b32 s73, s13, 0x40000000
  s_mov_b64 exec, 1
  ds_add_rtn_u32 v23, v249, v250 offset:8328
  s_mov_b64 exec, -1
  buffer_load_dwordx4 v[88:91], v4, s[36:39], s73 offen offset:0 nt
  buffer_load_dwordx4 v[92:95], v4, s[36:39], s73 offen offset:256 nt
  buffer_load_dwordx4 v[96:99], v4, s[36:39], s73 offen offset:512 nt
  buffer_load_dwordx4 v[100:103], v4, s[36:39], s73 offen offset:768 nt
  buffer_load_dwordx4 v[104:107], v4, s[40:43], s73 offen offset:0 nt
  buffer_load_dwordx4 v[108:111], v4, s[40:43], s73 offen offset:256 nt
  buffer_load_dwordx4 v[112:115], v4, s[40:43], s73 offen offset:512 nt
  buffer_load_dwordx4 v[116:119], v4, s[40:43], s73 offen offset:768 nt
  s_waitcnt vmcnt(28)
  v_mfma_f32_16x16x32_bf16 v[48:51], v[120:123], v[24:27], 0
  v_mfma_f32_16x16x32_bf16 v[48:51], v[124:127], v[28:31], v[48:51]
  v_mfma_f32_16x16x32_bf16 v[48:51], v[128:131], v[32:35], v[48:51]
  v_mfma_f32_16x16x32_bf16 v[48:51], v[132:135], v[36:39], v[48:51]
  s_nop 7
  s_waitcnt vmcnt(24)
  v_cvt_pk_bf16_f32 v16, v48, v49
  v_lshlrev_b32 v48, 16, v16
  v_and_b32 v49, 0xffff0000, v16
  v_mul_f32 v48, s68, v48
  v_mul_f32 v49, s68, v49
  v_cvt_pk_bf16_f32 v16, v48, v49
  v_lshlrev_b32 v48, 16, v16
  v_and_b32 v49, 0xffff0000, v16
  v_cvt_pk_bf16_f32 v16, v50, v51
  v_lshlrev_b32 v50, 16, v16
  v_and_b32 v51, 0xffff0000, v16
  v_mul_f32 v50, s68, v50
  v_mul_f32 v51, s68, v51
  v_cvt_pk_bf16_f32 v16, v50, v51
  v_lshlrev_b32 v50, 16, v16
  v_and_b32 v51, 0xffff0000, v16
  v_max3_f32 v8, v48, v49, v5
  v_max3_f32 v8, v50, v51, v8
  v_sub_f32 v9, v5, v8
  v_mul_f32 v10, s67, v8
  v_mul_f32 v9, s67, v9
  v_fma_f32 v12, v48, s67, -v10
  v_fma_f32 v13, v49, s67, -v10
  v_fma_f32 v14, v50, s67, -v10
  v_fma_f32 v15, v51, s67, -v10
  v_exp_f32 v9, v9
  v_exp_f32 v12, v12
  v_exp_f32 v13, v13
  v_exp_f32 v14, v14
  v_exp_f32 v15, v15
  v_mov_b32 v5, v8
  v_mul_f32 v40, v9, v40
  v_mul_f32 v41, v9, v41
  v_mul_f32 v42, v9, v42
  v_mul_f32 v43, v9, v43
  v_mul_f32 v44, v9, v44
  v_mul_f32 v45, v9, v45
  v_mul_f32 v46, v9, v46
  v_mul_f32 v47, v9, v47
  v_cvt_pk_bf16_f32 v18, v12, v13
  v_cvt_pk_bf16_f32 v19, v14, v15
  v_add_f32 v16, v12, v13
  v_add_f32 v17, v14, v15
  v_add_f32 v16, v16, v17
  v_fma_f32 v6, v6, v9, v16
  v_perm_b32 v20, v140, v136, s65
  v_perm_b32 v21, v140, v136, s66
  v_dot2_f32_bf16 v40, v20, v18, v40
  v_dot2_f32_bf16 v41, v21, v18, v41
  v_perm_b32 v22, v141, v137, s65
  v_perm_b32 v11, v141, v137, s66
  v_dot2_f32_bf16 v42, v22, v18, v42
  v_dot2_f32_bf16 v43, v11, v18, v43
  v_perm_b32 v20, v142, v138, s65
  v_perm_b32 v21, v142, v138, s66
  v_dot2_f32_bf16 v44, v20, v18, v44
  v_dot2_f32_bf16 v45, v21, v18, v45
  v_perm_b32 v22, v143, v139, s65
  v_perm_b32 v11, v143, v139, s66
  v_dot2_f32_bf16 v46, v22, v18, v46
  v_dot2_f32_bf16 v47, v11, v18, v47
  v_perm_b32 v20, v148, v144, s65
  v_perm_b32 v21, v148, v144, s66
  v_dot2_f32_bf16 v40, v20, v19, v40
  v_dot2_f32_bf16 v41, v21, v19, v41
  v_perm_b32 v22, v149, v145, s65
  v_perm_b32 v11, v149, v145, s66
  v_dot2_f32_bf16 v42, v22, v19, v42
  v_dot2_f32_bf16 v43, v11, v19, v43
  v_perm_b32 v20, v150, v146, s65
  v_perm_b32 v21, v150, v146, s66
  v_dot2_f32_bf16 v44, v20, v19, v44
  v_dot2_f32_bf16 v45, v21, v19, v45
  v_perm_b32 v22, v151, v147, s65
  v_perm_b32 v11, v151, v147, s66
  v_dot2_f32_bf16 v46, v22, v19, v46
  v_dot2_f32_bf16 v47, v11, v19, v47
  s_cmp_eq_u32 s75, 0x40000000
  s_cbranch_scc1 L1_exit
  s_waitcnt lgkmcnt(0)
  v_readfirstlane_b32 s61, v23
  s_lshr_b32 s12, s61, 2
  s_lshl_b32 s13, s12, 2
  s_add_u32 s13, s13, s64
  s_sub_u32 s14, s12, s8
  s_add_u32 s14, s14, s9
  s_cmp_lt_u32 s12, s8
  s_cselect_b32 s13, s13, s14
  s_lshl_b32 s13, s13, 14
  s_and_b32 s12, s61, 3
  s_lshl_b32 s12, s12, 12
  s_add_u32 s13, s13, s12
  s_add_u32 s13, s13, s60
  s_cmp_lt_u32 s61, s10
  s_cselect_b32 s74, s13, 0x40000000
  s_mov_b64 exec, 1
  ds_add_rtn_u32 v23, v249, v250 offset:8328
  s_mov_b64 exec, -1
  buffer_load_dwordx4 v[120:123], v3, s[36:39], s74 offen offset:0 nt
  buffer_load_dwordx4 v[124:127], v3, s[36:39], s74 offen offset:64 nt
  buffer_load_dwordx4 v[128:131], v3, s[36:39], s74 offen offset:128 nt
  buffer_load_dwordx4 v[132:135], v3, s[36:39], s74 offen offset:192 nt
  buffer_load_dwordx4 v[136:139], v4, s[40:43], s74 offen offset:0 nt
  buffer_load_dwordx4 v[140:143], v4, s[40:43], s74 offen offset:256 nt
  buffer_load_dwordx4 v[144:147], v4, s[40:43], s74 offen offset:512 nt
  buffer_load_dwordx4 v[148:151], v4, s[40:43], s74 offen offset:768 nt
  s_waitcnt vmcnt(28)
  v_dot2_f32_bf16 v48, v152, v52, 0
  v_dot2_f32_bf16 v49, v156, v52, 0
  v_dot2_f32_bf16 v50, v160, v52, 0
  v_dot2_f32_bf16 v51, v164, v52, 0
  v_dot2_f32_bf16 v48, v153, v53, v48
  v_dot2_f32_bf16 v49, v157, v53, v49
  v_dot2_f32_bf16 v50, v161, v53, v50
  v_dot2_f32_bf16 v51, v165, v53, v51
  v_dot2_f32_bf16 v48, v154, v54, v48
  v_dot2_f32_bf16 v49, v158, v54, v49
  v_dot2_f32_bf16 v50, v162, v54, v50
  v_dot2_f32_bf16 v51, v166, v54, v51
  v_dot2_f32_bf16 v48, v155, v55, v48
  v_dot2_f32_bf16 v49, v159, v55, v49
  v_dot2_f32_bf16 v50, v163, v55, v50
  v_dot2_f32_bf16 v51, v167, v55, v51
  s_nop 0
  v_add_f32_dpp v48, v48, v48 row_ror:8 row_mask:0xf bank_mask:0xf
  v_add_f32_dpp v49, v49, v49 row_ror:8 row_mask:0xf bank_mask:0xf
  v_add_f32_dpp v50, v50, v50 row_ror:8 row_mask:0xf bank_mask:0xf
  v_add_f32_dpp v51, v51, v51 row_ror:8 row_mask:0xf bank_mask:0xf
  v_add_f32_dpp v48, v48, v48 row_ror:4 row_mask:0xf bank_mask:0xf
  v_add_f32_dpp v49, v49, v49 row_ror:4 row_mask:0xf bank_mask:0xf
  v_add_f32_dpp v50, v50, v50 row_ror:4 row_mask:0xf bank_mask:0xf
  v_add_f32_dpp v51, v51, v51 row_ror:4 row_mask:0xf bank_mask:0xf
  v_add_f32_dpp v48, v48, v48 row_ror:2 row_mask:0xf bank_mask:0xf
  v_add_f32_dpp v49, v49, v49 row_ror:2 row_mask:0xf bank_mask:0xf
  v_add_f32_dpp v50, v50, v50 row_ror:2 row_mask:0xf bank_mask:0xf
  v_add_f32_dpp v51, v51, v51 row_ror:2 row_mask:0xf bank_mask:0xf
  v_add_f32_dpp v48, v48, v48 row_ror:1 row_mask:0xf bank_mask:0xf
  v_add_f32_dpp v49, v49, v49 row_ror:1 row_mask:0xf bank_mask:0xf
  v_add_f32_dpp v50, v50, v50 row_ror:1 row_mask:0xf bank_mask:0xf
  v_add_f32_dpp v51, v51, v51 row_ror:1 row_mask:0xf bank_mask:0xf
  s_waitcnt vmcnt(24)
  v_cvt_pk_bf16_f32 v16, v48, v49
  v_lshlrev_b32 v48, 16, v16
  v_and_b32 v49, 0xffff0000, v16
  v_mul_f32 v48, s68, v48
  v_mul_f32 v49, s68, v49
  v_cvt_pk_bf16_f32 v16, v48, v49
  v_lshlrev_b32 v48, 16, v16
  v_and_b32 v49, 0xffff0000, v16
  v_cvt_pk_bf16_f32 v16, v50, v51
  v_lshlrev_b32 v50, 16, v16
  v_and_b32 v51, 0xffff0000, v16
  v_mul_f32 v50, s68, v50
  v_mul_f32 v51, s68, v51
  v_cvt_pk_bf16_f32 v16, v50, v51
  v_lshlrev_b32 v50, 16, v16
  v_and_b32 v51, 0xffff0000, v16
  v_max3_f32 v8, v48, v49, v5
  v_max3_f32 v8, v50, v51, v8
  v_sub_f32 v9, v5, v8
  v_mul_f32 v10, s67, v8
  v_mul_f32 v9, s67, v9
  v_fma_f32 v12, v48, s67, -v10
  v_fma_f32 v13, v49, s67, -v10
  v_fma_f32 v14, v50, s67, -v10
  v_fma_f32 v15, v51, s67, -v10
  v_exp_f32 v9, v9
  v_exp_f32 v12, v12
  v_exp_f32 v13, v13
  v_exp_f32 v14, v14
  v_exp_f32 v15, v15
  v_mov_b32 v5, v8
  v_mul_f32 v40, v9, v40
  v_mul_f32 v41, v9, v41
  v_mul_f32 v42, v9, v42
  v_mul_f32 v43, v9, v43
  v_mul_f32 v44, v9, v44
  v_mul_f32 v45, v9, v45
  v_mul_f32 v46, v9, v46
  v_mul_f32 v47, v9, v47
  v_cvt_pk_bf16_f32 v18, v12, v13
  v_cvt_pk_bf16_f32 v19, v14, v15
  v_add_f32 v16, v12, v13
  v_add_f32 v17, v14, v15
  v_add_f32 v16, v16, v17
  v_fma_f32 v6, v6, v9, v16
  v_perm_b32 v20, v172, v168, s65
  v_perm_b32 v21, v172, v168, s66
  v_dot2_f32_bf16 v40, v20, v18, v40
  v_dot2_f32_bf16 v41, v21, v18, v41
  v_perm_b32 v22, v173, v169, s65
  v_perm_b32 v11, v173, v169, s66
  v_dot2_f32_bf16 v42, v22, v18, v42
  v_dot2_f32_bf16 v43, v11, v18, v43
  v_perm_b32 v20, v174, v170, s65
  v_perm_b32 v21, v174, v170, s66
  v_dot2_f32_bf16 v44, v20, v18, v44
  v_dot2_f32_bf16 v45, v21, v18, v45
  v_perm_b32 v22, v175, v171, s65
  v_perm_b32 v11, v175, v171, s66
  v_dot2_f32_bf16 v46, v22, v18, v46
  v_dot2_f32_bf16 v47, v11, v18, v47
  v_perm_b32 v20, v180, v176, s65
  v_perm_b32 v21, v180, v176, s66
  v_dot2_f32_bf16 v40, v20, v19, v40
  v_dot2_f32_bf16 v41, v21, v19, v41
  v_perm_b32 v22, v181, v177, s65
  v_perm_b32 v11, v181, v177, s66
  v_dot2_f32_bf16 v42, v22, v19, v42
  v_dot2_f32_bf16 v43, v11, v19, v43
  v_perm_b32 v20, v182, v178, s65
  v_perm_b32 v21, v182, v178, s66
  v_dot2_f32_bf16 v44, v20, v19, v44
  v_dot2_f32_bf16 v45, v21, v19, v45
  v_perm_b32 v22, v183, v179, s65
  v_perm_b32 v11, v183, v179, s66
  v_dot2_f32_bf16 v46, v22, v19, v46
  v_dot2_f32_bf16 v47, v11, v19, v47
  s_cmp_eq_u32 s72, 0x40000000
  s_cbranch_scc1 L1_exit
  s_waitcnt lgkmcnt(0)
  v_readfirstlane_b32 s61, v23
  s_lshr_b32 s12, s61, 2
  s_lshl_b32 s13, s12, 2
  s_add_u32 s13, s13, s64
  s_sub_u32 s14, s12, s8
  s_add_u32 s14, s14, s9
  s_cmp_lt_u32 s12, s8
  s_cselect_b32 s13, s13, s14
  s_lshl_b32 s13, s13, 14
  s_and_b32 s12, s61, 3
  s_lshl_b32 s12, s12, 12
  s_add_u32 s13, s13, s12
  s_add_u32 s13, s13, s60
  s_cmp_lt_u32 s61, s10
  s_cselect_b32 s75, s13, 0x40000000
  s_mov_b64 exec, 1
  ds_add_rtn_u32 v23, v249, v250 offset:8328
  s_mov_b64 exec, -1
  buffer_load_dwordx4 v[152:155], v4, s[36:39], s75 offen offset:0 nt
  buffer_load_dwordx4 v[156:159], v4, s[36:39], s75 offen offset:256 nt
  buffer_load_dwordx4 v[160:163], v4, s[36:39], s75 offen offset:512 nt
  buffer_load_dwordx4 v[164:167], v4, s[36:39], s75 offen offset:768 nt
  buffer_load_dwordx4 v[168:171], v4, s[40:43], s75 offen offset:0 nt
  buffer_load_dwordx4 v[172:175], v4, s[40:43], s75 offen offset:256 nt
  buffer_load_dwordx4 v[176:179], v4, s[40:43], s75 offen offset:512 nt
  buffer_load_dwordx4 v[180:183], v4, s[40:43], s75 offen offset:768 nt
  s_cmp_eq_u32 s86, 1
  s_cbranch_scc1 L1_body
  s_waitcnt lgkmcnt(0)
  s_lshl_b32 s61, s3, 2
  v_mov_b32 v20, s61
  ds_write_b32 v20, v250 offset:8336
  v_lshrrev_b32 v20, 2, v2
  v_lshl_add_u32 v20, v1, 3, v20
  v_lshlrev_b32 v20, 7, v20
  v_and_b32 v21, 3, v2
  v_lshl_add_u32 v20, v21, 3, v20
  v_add_u32 v20, s71, v20
  ds_read_b64_tr_b16 v[184:185], v20 offset:0
  ds_read_b64_tr_b16 v[186:187], v20 offset:512
  ds_read_b64_tr_b16 v[188:189], v20 offset:32
  ds_read_b64_tr_b16 v[190:191], v20 offset:544
  ds_read_b64_tr_b16 v[192:193], v20 offset:64
  ds_read_b64_tr_b16 v[194:195], v20 offset:576
  ds_read_b64_tr_b16 v[196:197], v20 offset:96
  ds_read_b64_tr_b16 v[198:199], v20 offset:608
  ds_read_b64_tr_b16 v[200:201], v20 offset:4096
  ds_read_b64_tr_b16 v[202:203], v20 offset:4608
  ds_read_b64_tr_b16 v[204:205], v20 offset:4128
  ds_read_b64_tr_b16 v[206:207], v20 offset:4640
  ds_read_b64_tr_b16 v[208:209], v20 offset:4160
  ds_read_b64_tr_b16 v[210:211], v20 offset:4672
  ds_read_b64_tr_b16 v[212:213], v20 offset:4192
  ds_read_b64_tr_b16 v[214:215], v20 offset:4704
  ds_read_b64_tr_b16 v[216:217], v20 offset:8192
  ds_read_b64_tr_b16 v[218:219], v20 offset:8704
  ds_read_b64_tr_b16 v[220:221], v20 offset:8224
  ds_read_b64_tr_b16 v[222:223], v20 offset:8736
  ds_read_b64_tr_b16 v[224:225], v20 offset:8256
  ds_read_b64_tr_b16 v[226:227], v20 offset:8768
  ds_read_b64_tr_b16 v[228:229], v20 offset:8288
  ds_read_b64_tr_b16 v[230:231], v20 offset:8800
  ds_read_b64_tr_b16 v[232:233], v20 offset:12288
  ds_read_b64_tr_b16 v[234:235], v20 offset:12800
  ds_read_b64_tr_b16 v[236:237], v20 offset:12320
  ds_read_b64_tr_b16 v[238:239], v20 offset:12832
  ds_read_b64_tr_b16 v[240:241], v20 offset:12352
  ds_read_b64_tr_b16 v[242:243], v20 offset:12864
  ds_read_b64_tr_b16 v[244:245], v20 offset:12384
  ds_read_b64_tr_b16 v[246:247], v20 offset:12896
  s_waitcnt lgkmcnt(0)
  s_mov_b32 s86, 1
  s_branch L1_body
L1_exit:
  s_cmp_eq_u32 s86, 1
  s_cbranch_scc1 L1_comb
  s_cmp_eq_u32 s82, 1
  s_cbranch_scc1 L1_wo_issued
  s_add_u32 m0, s71, 0
  s_add_u32 s61, s83, 0
  buffer_load_dwordx4 v251, s[44:47], s61 offen lds
  s_add_u32 m0, s71, 1024
  s_add_u32 s61, s83, 8192
  buffer_load_dwordx4 v251, s[44:47], s61 offen lds
  s_add_u32 m0, s71, 2048
  s_add_u32 s61, s83, 16384
  buffer_load_dwordx4 v251, s[44:47], s61 offen lds
  s_add_u32 m0, s71, 3072
  s_add_u32 s61, s83, 24576
  buffer_load_dwordx4 v251, s[44:47], s61 offen lds
  s_add_u32 m0, s71, 4096
  s_add_u32 s61, s83, 32768
  buffer_load_dwordx4 v251, s[44:47], s61 offen lds
  s_add_u32 m0, s71, 5120
  s_add_u32 s61, s83, 40960
  buffer_load_dwordx4 v251, s[44:47], s61 offen lds
  s_add_u32 m0, s71, 6144
  s_add_u32 s61, s83, 49152
  buffer_load_dwordx4 v251, s[44:47], s61 offen lds
  s_add_u32 m0, s71, 7168
  s_add_u32 s61, s83, 57344
  buffer_load_dwordx4 v251, s[44:47], s61 offen lds
  s_add_u32 m0, s71, 8192
  s_add_u32 s61, s83, 65536
  buffer_load_dwordx4 v251, s[44:47], s61 offen lds
  s_add_u32 m0, s71, 9216
  s_add_u32 s61, s83, 73728
  buffer_load_dwordx4 v251, s[44:47], s61 offen lds
  s_add_u32 m0, s71, 10240
  s_add_u32 s61, s83, 81920
  buffer_load_dwordx4 v251, s[44:47], s61 offen lds
  s_add_u32 m0, s71, 11264
  s_add_u32 s61, s83, 90112
  buffer_load_dwordx4 v251, s[44:47], s61 offen lds
  s_add_u32 m0, s71, 12288
  s_add_u32 s61, s83, 98304
  buffer_load_dwordx4 v251, s[44:47], s61 offen lds
  s_add_u32 m0, s71, 13312
  s_add_u32 s61, s83, 106496
  buffer_load_dwordx4 v251, s[44:47], s61 offen lds
  s_add_u32 m0, s71, 14336
  s_add_u32 s61, s83, 114688
  buffer_load_dwordx4 v251, s[44:47], s61 offen lds
  s_add_u32 m0, s71, 15360
  s_add_u32 s61, s83, 122880
  buffer_load_dwordx4 v251, s[44:47], s61 offen lds
  s_add_u32 m0, s71, 65536
  s_add_u32 s61, s83, 512
  buffer_load_dwordx4 v251, s[44:47], s61 offen lds
  s_add_u32 m0, s71, 66560
  s_add_u32 s61, s83, 8704
  buffer_load_dwordx4 v251, s[44:47], s61 offen lds
  s_add_u32 m0, s71, 67584
  s_add_u32 s61, s83, 16896
  buffer_load_dwordx4 v251, s[44:47], s61 offen lds
  s_add_u32 m0, s71, 68608
  s_add_u32 s61, s83, 25088
  buffer_load_dwordx4 v251, s[44:47], s61 offen lds
  s_add_u32 m0, s71, 69632
  s_add_u32 s61, s83, 33280
  buffer_load_dwordx4 v251, s[44:47], s61 offen lds
  s_add_u32 m0, s71, 70656
  s_add_u32 s61, s83, 41472
  buffer_load_dwordx4 v251, s[44:47], s61 offen lds
  s_add_u32 m0, s71, 71680
  s_add_u32 s61, s83, 49664
  buffer_load_dwordx4 v251, s[44:47], s61 offen lds
  s_add_u32 m0, s71, 72704
  s_add_u32 s61, s83, 57856
  buffer_load_dwordx4 v251, s[44:47], s61 offen lds
  s_add_u32 m0, s71, 73728
  s_add_u32 s61, s83, 66048
  buffer_load_dwordx4 v251, s[44:47], s61 offen lds
  s_add_u32 m0, s71, 74752
  s_add_u32 s61, s83, 74240
  buffer_load_dwordx4 v251, s[44:47], s61 offen lds
  s_add_u32 m0, s71, 75776
  s_add_u32 s61, s83, 82432
  buffer_load_dwordx4 v251, s[44:47], s61 offen lds
  s_add_u32 m0, s71, 76800
  s_add_u32 s61, s83, 90624
  buffer_load_dwordx4 v251, s[44:47], s61 offen lds
  s_add_u32 m0, s71, 77824
  s_add_u32 s61, s83, 98816
  buffer_load_dwordx4 v251, s[44:47], s61 offen lds
  s_add_u32 m0, s71, 78848
  s_add_u32 s61, s83, 107008
  buffer_load_dwordx4 v251, s[44:47], s61 offen lds
  s_add_u32 m0, s71, 79872
  s_add_u32 s61, s83, 115200
  buffer_load_dwordx4 v251, s[44:47], s61 offen lds
  s_add_u32 m0, s71, 80896
  s_add_u32 s61, s83, 123392
  buffer_load_dwordx4 v251, s[44:47], s61 offen lds
L1_wo_issued:
  s_waitcnt vmcnt(0) lgkmcnt(0)
  s_lshl_b32 s61, s3, 2
  v_mov_b32 v20, s61
  ds_write_b32 v20, v250 offset:8336
  v_lshrrev_b32 v20, 2, v2
  v_lshl_add_u32 v20, v1, 3, v20
  v_lshlrev_b32 v20, 7, v20
  v_and_b32 v21, 3, v2
  v_lshl_add_u32 v20, v21, 3, v20
  v_add_u32 v20, s71, v20
  ds_read_b64_tr_b16 v[184:185], v20 offset:0
  ds_read_b64_tr_b16 v[186:187], v20 offset:512
  ds_read_b64_tr_b16 v[188:189], v20 offset:32
  ds_read_b64_tr_b16 v[190:191], v20 offset:544
  ds_read_b64_tr_b16 v[192:193], v20 offset:64
  ds_read_b64_tr_b16 v[194:195], v20 offset:576
  ds_read_b64_tr_b16 v[196:197], v20 offset:96
  ds_read_b64_tr_b16 v[198:199], v20 offset:608
  ds_read_b64_tr_b16 v[200:201], v20 offset:4096
  ds_read_b64_tr_b16 v[202:203], v20 offset:4608
  ds_read_b64_tr_b16 v[204:205], v20 offset:4128
  ds_read_b64_tr_b16 v[206:207], v20 offset:4640
  ds_read_b64_tr_b16 v[208:209], v20 offset:4160
  ds_read_b64_tr_b16 v[210:211], v20 offset:4672
  ds_read_b64_tr_b16 v[212:213], v20 offset:4192
  ds_read_b64_tr_b16 v[214:215], v20 offset:4704
  ds_read_b64_tr_b16 v[216:217], v20 offset:8192
  ds_read_b64_tr_b16 v[218:219], v20 offset:8704
  ds_read_b64_tr_b16 v[220:221], v20 offset:8224
  ds_read_b64_tr_b16 v[222:223], v20 offset:8736
  ds_read_b64_tr_b16 v[224:225], v20 offset:8256
  ds_read_b64_tr_b16 v[226:227], v20 offset:8768
  ds_read_b64_tr_b16 v[228:229], v20 offset:8288
  ds_read_b64_tr_b16 v[230:231], v20 offset:8800
  ds_read_b64_tr_b16 v[232:233], v20 offset:12288
  ds_read_b64_tr_b16 v[234:235], v20 offset:12800
  ds_read_b64_tr_b16 v[236:237], v20 offset:12320
  ds_read_b64_tr_b16 v[238:239], v20 offset:12832
  ds_read_b64_tr_b16 v[240:241], v20 offset:12352
  ds_read_b64_tr_b16 v[242:243], v20 offset:12864
  ds_read_b64_tr_b16 v[244:245], v20 offset:12384
  ds_read_b64_tr_b16 v[246:247], v20 offset:12896
  s_waitcnt lgkmcnt(0)
  s_mov_b32 s86, 1
L1_comb:
  v_mov_b32 v8, v5
  v_mov_b32 v9, v5
  s_nop 1
  v_permlane32_swap_b32 v8, v9
  v_max_f32 v8, v8, v9
  v_mov_b32 v9, v8
  s_nop 1
  v_permlane16_swap_b32 v8, v9
  v_max_f32 v10, v8, v9
  v_sub_f32 v11, v5, v10
  v_mul_f32 v11, s67, v11
  v_exp_f32 v11, v11
  s_nop 0
  v_mul_f32 v8, v11, v6
  v_mul_f32 v9, v11, v6
  v_mul_f32 v40, v11, v40
  v_mul_f32 v41, v11, v41
  v_mul_f32 v42, v11, v42
  v_mul_f32 v43, v11, v43
  v_mul_f32 v44, v11, v44
  v_mul_f32 v45, v11, v45
  v_mul_f32 v46, v11, v46
  v_mul_f32 v47, v11, v47
  v_permlane32_swap_b32 v8, v9
  v_add_f32 v8, v8, v9
  v_mov_b32 v9, v8
  s_nop 1
  v_permlane16_swap_b32 v8, v9
  v_add_f32 v11, v8, v9
  s_nop 2
  v_permlane32_swap_b32 v40, v44
  v_permlane32_swap_b32 v41, v45
  v_permlane32_swap_b32 v42, v46
  v_permlane32_swap_b32 v43, v47
  v_add_f32 v40, v40, v44
  v_add_f32 v41, v41, v45
  v_add_f32 v42, v42, v46
  v_add_f32 v43, v43, v47
  s_nop 1
  v_permlane16_swap_b32 v40, v42
  v_permlane16_swap_b32 v41, v43
  v_add_f32 v40, v40, v42
  v_add_f32 v41, v41, v43
  ds_write_b64 v7, v[40:41] offset:4096
  s_lshl_b32 s61, s3, 3
  v_mov_b32 v8, s61
  ds_write_b64 v8, v[10:11] offset:8192
  v_lshlrev_b32 v5, 3, v0
  s_lshl_b32 s61, s3, 9
  s_add_u32 s61, s61, 8448
  v_lshlrev_b32 v6, 2, v0
  v_add_u32 v6, s61, v6
  v_and_b32 v48, 1, v2
  v_lshlrev_b32 v48, 8, v48
  v_lshl_add_u32 v48, v1, 4, v48
  v_add_u32 v48, s61, v48
  v_and_b32 v9, 2, v2
  v_cmp_eq_u32 s[16:17], 0, v9
  v_lshlrev_b32 v3, 2, v2
  v_lshl_add_u32 v3, v1, 13, v3
  v_cmp_eq_u32 s[18:19], 1, v1
  v_cmp_eq_u32 s[20:21], 2, v1
  v_cmp_eq_u32 s[22:23], 3, v1
  s_lshl_b32 s61, s63, 5
  s_lshl_b32 s69, s3, 2
  s_add_u32 s61, s61, s69
  s_lshl_b32 s61, s61, 13
  s_lshl_b32 s69, s62, 2
  s_add_u32 s69, s69, s64
  s_lshl_b32 s70, s69, 6
  s_add_u32 s60, s61, s70
  s_waitcnt vmcnt(0)
  v_mov_b32 v72, 0
  v_mov_b32 v73, 0
  v_mov_b32 v74, 0
  v_mov_b32 v75, 0
  v_mov_b32 v76, 0
  v_mov_b32 v77, 0
  v_mov_b32 v78, 0
  v_mov_b32 v79, 0
  v_mov_b32 v80, 0
  v_mov_b32 v81, 0
  v_mov_b32 v82, 0
  v_mov_b32 v83, 0
  v_mov_b32 v84, 0
  v_mov_b32 v85, 0
  v_mov_b32 v86, 0
  v_mov_b32 v87, 0
  s_waitcnt lgkmcnt(0)
  s_barrier
  v_mov_b32 v8, 0
  ds_read_b128 v[24:27], v8 offset:8192
  ds_read_b128 v[28:31], v8 offset:8208
  ds_read_b128 v[32:35], v8 offset:8224
  ds_read_b128 v[36:39], v8 offset:8240
  ds_read_b64 v[56:57], v5 offset:4096
  ds_read_b64 v[58:59], v5 offset:4608
  ds_read_b64 v[60:61], v5 offset:5120
  ds_read_b64 v[62:63], v5 offset:5632
  ds_read_b64 v[64:65], v5 offset:6144
  ds_read_b64 v[66:67], v5 offset:6656
  ds_read_b64 v[68:69], v5 offset:7168
  ds_read_b64 v[70:71], v5 offset:7680
  s_waitcnt lgkmcnt(8)
  v_max3_f32 v12, v24, v26, v28
  v_max3_f32 v12, v30, v32, v12
  v_max3_f32 v12, v34, v36, v12
  v_max_f32 v12, v38, v12
  v_sub_f32 v24, v24, v12
  v_sub_f32 v26, v26, v12
  v_sub_f32 v28, v28, v12
  v_sub_f32 v30, v30, v12
  v_sub_f32 v32, v32, v12
  v_sub_f32 v34, v34, v12
  v_sub_f32 v36, v36, v12
  v_sub_f32 v38, v38, v12
  v_mul_f32 v24, s67, v24
  v_mul_f32 v26, s67, v26
  v_mul_f32 v28, s67, v28
  v_mul_f32 v30, s67, v30
  v_mul_f32 v32, s67, v32
  v_mul_f32 v34, s67, v34
  v_mul_f32 v36, s67, v36
  v_mul_f32 v38, s67, v38
  v_exp_f32 v24, v24
  v_exp_f32 v26, v26
  v_exp_f32 v28, v28
  v_exp_f32 v30, v30
  v_exp_f32 v32, v32
  v_exp_f32 v34, v34
  v_exp_f32 v36, v36
  v_exp_f32 v38, v38
  s_waitcnt lgkmcnt(0)
  v_mul_f32 v14, v24, v56
  v_mul_f32 v15, v24, v57
  v_fma_f32 v14, v26, v58, v14
  v_fma_f32 v15, v26, v59, v15
  v_fma_f32 v14, v28, v60, v14
  v_fma_f32 v15, v28, v61, v15
  v_fma_f32 v14, v30, v62, v14
  v_fma_f32 v15, v30, v63, v15
  v_fma_f32 v14, v32, v64, v14
  v_fma_f32 v15, v32, v65, v15
  v_fma_f32 v14, v34, v66, v14
  v_fma_f32 v15, v34, v67, v15
  v_fma_f32 v14, v36, v68, v14
  v_fma_f32 v15, v36, v69, v15
  v_fma_f32 v14, v38, v70, v14
  v_fma_f32 v15, v38, v71, v15
  v_cvt_pk_bf16_f32 v16, v14, v15
  v_lshlrev_b32 v8, 16, v16
  v_and_b32 v9, 0xffff0000, v16
  v_sub_f32 v14, v14, v8
  v_sub_f32 v15, v15, v9
  v_cvt_pk_bf16_f32 v17, v14, v15
  ds_write_b32 v6, v16
  ds_write_b32 v6, v17 offset:256
  v_mul_f32 v13, v24, v25
  v_fma_f32 v13, v26, v27, v13
  v_fma_f32 v13, v28, v29, v13
  v_fma_f32 v13, v30, v31, v13
  v_fma_f32 v13, v32, v33, v13
  v_fma_f32 v13, v34, v35, v13
  v_fma_f32 v13, v36, v37, v13
  v_fma_f32 v13, v38, v39, v13
  s_waitcnt lgkmcnt(0)
  s_mov_b64 exec, s[16:17]
  ds_read_b128 v[72:75], v48 offset:0
  ds_read_b128 v[76:79], v48 offset:64
  ds_read_b128 v[80:83], v48 offset:128
  ds_read_b128 v[84:87], v48 offset:192
  s_mov_b64 exec, -1
  s_waitcnt lgkmcnt(3)
  v_mfma_f32_16x16x32_bf16 v[88:91], v[72:75], v[184:187], 0
  v_mfma_f32_16x16x32_bf16 v[92:95], v[72:75], v[188:191], 0
  v_mfma_f32_16x16x32_bf16 v[96:99], v[72:75], v[192:195], 0
  v_mfma_f32_16x16x32_bf16 v[100:103], v[72:75], v[196:199], 0
  s_waitcnt lgkmcnt(2)
  v_mfma_f32_16x16x32_bf16 v[88:91], v[76:79], v[200:203], v[88:91]
  v_mfma_f32_16x16x32_bf16 v[92:95], v[76:79], v[204:207], v[92:95]
  v_mfma_f32_16x16x32_bf16 v[96:99], v[76:79], v[208:211], v[96:99]
  v_mfma_f32_16x16x32_bf16 v[100:103], v[76:79], v[212:215], v[100:103]
  s_waitcnt lgkmcnt(1)
  v_mfma_f32_16x16x32_bf16 v[88:91], v[80:83], v[216:219], v[88:91]
  v_mfma_f32_16x16x32_bf16 v[92:95], v[80:83], v[220:223], v[92:95]
  v_mfma_f32_16x16x32_bf16 v[96:99], v[80:83], v[224:227], v[96:99]
  v_mfma_f32_16x16x32_bf16 v[100:103], v[80:83], v[228:231], v[100:103]
  s_waitcnt lgkmcnt(0)
  v_mfma_f32_16x16x32_bf16 v[88:91], v[84:87], v[232:235], v[88:91]
  v_mfma_f32_16x16x32_bf16 v[92:95], v[84:87], v[236:239], v[92:95]
  v_mfma_f32_16x16x32_bf16 v[96:99], v[84:87], v[240:243], v[96:99]
  v_mfma_f32_16x16x32_bf16 v[100:103], v[84:87], v[244:247], v[100:103]
  s_nop 7
  v_add_f32 v40, v88, v89
  v_add_f32 v41, v92, v93
  v_add_f32 v42, v96, v97
  v_add_f32 v43, v100, v101
  v_cndmask_b32 v40, v40, v41, s[18:19]
  v_cndmask_b32 v40, v40, v42, s[20:21]
  v_cndmask_b32 v40, v40, v43, s[22:23]
  buffer_store_dword v40, v3, s[48:51], s60 offen
  s_cmp_eq_u32 s84, 1
  s_cbranch_scc0 L1_noffn
  s_lshl_b32 s61, s85, 6
  s_add_u32 s61, s61, 1048576
  s_add_u32 s70, s61, 131072
  buffer_store_dwordx4 v[120:123], v136, s[48:51], s61 offen
  buffer_store_dwordx4 v[124:127], v136, s[48:51], s61 offen offset:16
  buffer_store_dwordx4 v[128:131], v136, s[48:51], s70 offen
  buffer_store_dwordx4 v[132:135], v136, s[48:51], s70 offen offset:16
L1_noffn:
  s_cmp_lg_u32 s3, 0
  s_cbranch_scc1 L1_done
  s_lshl_b32 s61, s63, 7
  s_add_u32 s61, s61, s69
  s_lshl_b32 s61, s61, 3
  s_add_u32 s61, s61, 524288
  v_mov_b32 v8, 0
  v_cmp_eq_u32 vcc, 0, v0
  s_and_saveexec_b64 s[70:71], vcc
  buffer_store_dwordx2 v[12:13], v8, s[48:51], s61 offen
L1_done:
  s_endpgm
.globl fin_kernel
.p2align 8
.type fin_kernel,@function
fin_kernel:
  s_cmp_ge_u32 s2, 64
  s_cbranch_scc1 L2_done
  s_load_dwordx2 s[4:5], s[0:1], 0
  s_load_dwordx8 s[20:27], s[0:1], 64
  v_lshrrev_b32 v1, 6, v0
  v_and_b32 v2, 15, v0
  v_lshrrev_b32 v3, 4, v0
  v_readfirstlane_b32 s3, v1
  s_lshr_b32 s63, s2, 5
  v_lshlrev_b32 v4, 2, v2
  v_lshl_add_u32 v4, v3, 9, v4
  v_lshlrev_b32 v5, 6, v3
  v_lshlrev_b32 v6, 8, v3
  v_lshl_add_u32 v6, v2, 2, v6
  v_lshlrev_b32 v7, 2, v0
  s_lshl_b32 s60, s2, 13
  s_lshl_b32 s61, s63, 10
  s_add_u32 s62, s61, 524288
  s_lshl_b32 s64, s2, 12
  s_add_u32 s64, s64, 1048576
  s_waitcnt lgkmcnt(0)
  s_mov_b32 s48, s26
  s_mov_b32 s49, s27
  s_mov_b32 s50, 0x20000000
  s_mov_b32 s51, 0x00020000
  s_mov_b32 s28, s4
  s_mov_b32 s29, s5
  s_mov_b32 s30, 0x800
  s_mov_b32 s31, 0x00020000
  s_mov_b32 s32, s20
  s_mov_b32 s33, s21
  s_mov_b32 s34, 0x400
  s_mov_b32 s35, 0x00020000
  s_mov_b32 s36, s22
  s_mov_b32 s37, s23
  s_mov_b32 s38, 0x800
  s_mov_b32 s39, 0x00020000
  buffer_load_dwordx4 v[24:27], v5, s[48:51], s62 offen offset:0
  buffer_load_dwordx4 v[28:31], v5, s[48:51], s62 offen offset:16
  buffer_load_dwordx4 v[32:35], v5, s[48:51], s62 offen offset:32
  buffer_load_dwordx4 v[36:39], v5, s[48:51], s62 offen offset:48
  buffer_load_dword v16, v4, s[48:51], s60 offen offset:0
  buffer_load_dword v17, v4, s[48:51], s60 offen offset:64
  buffer_load_dword v18, v4, s[48:51], s60 offen offset:128
  buffer_load_dword v19, v4, s[48:51], s60 offen offset:192
  buffer_load_dword v20, v4, s[48:51], s60 offen offset:256
  buffer_load_dword v21, v4, s[48:51], s60 offen offset:320
  buffer_load_dword v22, v4, s[48:51], s60 offen offset:384
  buffer_load_dword v23, v4, s[48:51], s60 offen offset:448
  v_mov_b32 v40, 0
  v_mov_b32 v41, 0
  v_mov_b32 v42, 0
  v_mov_b32 v43, 0
  v_cmp_gt_u32 vcc, 14, v3
  s_and_saveexec_b64 s[70:71], vcc
  buffer_load_dword v40, v6, s[48:51], s64 offen offset:0
  buffer_load_dword v41, v6, s[48:51], s64 offen offset:64
  buffer_load_dword v42, v6, s[48:51], s64 offen offset:128
  buffer_load_dword v43, v6, s[48:51], s64 offen offset:192
  s_mov_b64 exec, s[70:71]
  buffer_load_dword v54, v7, s[28:31], s61 offen
  buffer_load_dword v55, v7, s[32:35], 0 offen
  s_mov_b32 s67, 0x3fb8aa3b
  s_waitcnt vmcnt(14)
  v_max3_f32 v8, v24, v26, v28
  v_max_f32 v8, v30, v8
  v_sub_f32 v24, v24, v8
  v_sub_f32 v26, v26, v8
  v_sub_f32 v28, v28, v8
  v_sub_f32 v30, v30, v8
  v_mul_f32 v24, s67, v24
  v_mul_f32 v26, s67, v26
  v_mul_f32 v28, s67, v28
  v_mul_f32 v30, s67, v30
  v_exp_f32 v24, v24
  v_exp_f32 v26, v26
  v_exp_f32 v28, v28
  v_exp_f32 v30, v30
  s_nop 0
  v_mul_f32 v9, v24, v25
  v_fma_f32 v9, v26, v27, v9
  v_fma_f32 v9, v28, v29, v9
  v_fma_f32 v9, v30, v31, v9
  v_rcp_f32 v9, v9
  v_max3_f32 v10, v32, v34, v36
  v_max_f32 v10, v38, v10
  v_sub_f32 v32, v32, v10
  v_sub_f32 v34, v34, v10
  v_sub_f32 v36, v36, v10
  v_sub_f32 v38, v38, v10
  v_mul_f32 v32, s67, v32
  v_mul_f32 v34, s67, v34
  v_mul_f32 v36, s67, v36
  v_mul_f32 v38, s67, v38
  v_exp_f32 v32, v32
  v_exp_f32 v34, v34
  v_exp_f32 v36, v36
  v_exp_f32 v38, v38
  s_nop 0
  v_mul_f32 v11, v32, v33
  v_fma_f32 v11, v34, v35, v11
  v_fma_f32 v11, v36, v37, v11
  v_fma_f32 v11, v38, v39, v11
  v_rcp_f32 v11, v11
  s_waitcnt vmcnt(6)
  v_mul_f32 v8, v24, v16
  v_fma_f32 v8, v26, v17, v8
  v_fma_f32 v8, v28, v18, v8
  v_fma_f32 v8, v30, v19, v8
  v_mul_f32 v10, v32, v20
  v_fma_f32 v10, v34, v21, v10
  v_fma_f32 v10, v36, v22, v10
  v_fma_f32 v10, v38, v23, v10
  v_mul_f32 v12, v8, v9
  v_fma_f32 v12, v10, v11, v12
  s_waitcnt vmcnt(2)
  v_add_f32 v13, v40, v41
  v_add_f32 v14, v42, v43
  v_add_f32 v13, v13, v14
  s_waitcnt vmcnt(0)
  v_lshlrev_b32 v56, 16, v54
  v_and_b32 v57, 0xffff0000, v54
  v_lshlrev_b32 v58, 16, v55
  v_and_b32 v59, 0xffff0000, v55
  v_mul_f32 v56, v56, v58
  v_mul_f32 v57, v57, v59
  v_cvt_pk_bf16_f32 v56, v56, v57
  v_lshlrev_b32 v57, 16, v56
  v_and_b32 v56, 0xffff0000, v56
  v_add_f32 v14, v56, v57
  v_permlane32_swap_b32 v12, v13
  v_add_f32 v12, v12, v13
  v_mov_b32 v13, v12
  v_mov_b32 v15, v14
  s_nop 0
  v_permlane16_swap_b32 v12, v13
  v_permlane32_swap_b32 v14, v15
  v_add_f32 v12, v12, v13
  v_add_f32 v14, v14, v15
  v_mov_b32 v15, v14
  s_nop 1
  v_permlane16_swap_b32 v14, v15
  v_add_f32 v14, v14, v15
  s_nop 1
  v_add_f32_dpp v14, v14, v14 row_ror:8 row_mask:0xf bank_mask:0xf
  s_nop 1
  v_add_f32_dpp v14, v14, v14 row_ror:4 row_mask:0xf bank_mask:0xf
  s_nop 1
  v_add_f32_dpp v14, v14, v14 row_ror:2 row_mask:0xf bank_mask:0xf
  s_nop 1
  v_add_f32_dpp v14, v14, v14 row_ror:1 row_mask:0xf bank_mask:0xf
  v_and_b32 v4, 63, v0
  v_lshrrev_b32 v5, 5, v4
  v_lshlrev_b32 v5, 6, v5
  v_lshl_add_u32 v5, v2, 2, v5
  s_lshl_b32 s61, s3, 7
  v_add_u32 v5, s61, v5
  ds_write_b32 v5, v12
  s_lshl_b32 s61, s3, 2
  v_mov_b32 v6, s61
  ds_write_b32 v6, v14 offset:512
  s_waitcnt lgkmcnt(0)
  s_barrier
  s_cmp_lg_u32 s3, 0
  s_cbranch_scc1 L2_done
  v_lshlrev_b32 v5, 2, v2
  ds_read_b32 v16, v5 offset:0
  ds_read_b32 v20, v5 offset:64
  ds_read_b32 v17, v5 offset:128
  ds_read_b32 v21, v5 offset:192
  ds_read_b32 v18, v5 offset:256
  ds_read_b32 v22, v5 offset:320
  ds_read_b32 v19, v5 offset:384
  ds_read_b32 v23, v5 offset:448
  v_mov_b32 v6, 0
  ds_read_b128 v[24:27], v6 offset:512
  s_waitcnt lgkmcnt(0)
  v_add_f32 v16, v16, v17
  v_add_f32 v18, v18, v19
  v_add_f32 v16, v16, v18
  v_add_f32 v20, v20, v21
  v_add_f32 v22, v22, v23
  v_add_f32 v20, v20, v22
  v_add_f32 v24, v24, v25
  v_add_f32 v26, v26, v27
  v_add_f32 v24, v24, v26
  v_cvt_pk_bf16_f32 v16, v16, v16
  v_lshlrev_b32 v16, 16, v16
  v_cvt_pk_bf16_f32 v20, v20, v20
  v_lshlrev_b32 v20, 16, v20
  v_cvt_pk_bf16_f32 v24, v24, v24
  v_lshlrev_b32 v24, 16, v24
  v_mul_f32 v24, 0xbfb8aa3b, v24
  v_exp_f32 v24, v24
  s_nop 0
  v_add_f32 v24, 1.0, v24
  v_rcp_f32 v24, v24
  s_nop 0
  v_cvt_pk_bf16_f32 v24, v24, v24
  v_lshlrev_b32 v24, 16, v24
  v_sub_f32 v25, 1.0, v24
  v_cvt_pk_bf16_f32 v25, v25, v25
  v_lshlrev_b32 v25, 16, v25
  v_mul_f32 v16, v24, v16
  v_cvt_pk_bf16_f32 v16, v16, v16
  v_lshlrev_b32 v16, 16, v16
  v_mul_f32 v20, v25, v20
  v_cvt_pk_bf16_f32 v20, v20, v20
  v_lshlrev_b32 v20, 16, v20
  v_add_f32 v16, v16, v20
  v_cvt_pk_bf16_f32 v16, v16, v16
  s_lshl_b32 s61, s2, 5
  v_lshlrev_b32 v5, 1, v2
  v_cmp_gt_u32 vcc, 16, v0
  s_and_saveexec_b64 s[70:71], vcc
  buffer_store_short v16, v5, s[36:39], s61 offen
L2_done:
  s_endpgm
L2_codeend:
.section .rodata,"a"
.p2align 6
.amdhsa_kernel attn_kernel
  .amdhsa_next_free_vgpr 254
  .amdhsa_next_free_sgpr 102
  .amdhsa_accum_offset 256
  .amdhsa_group_segment_fixed_size 0
  .amdhsa_kernarg_size 96
  .amdhsa_user_sgpr_count 2
  .amdhsa_user_sgpr_kernarg_segment_ptr 1
  .amdhsa_system_sgpr_workgroup_id_x 1
.end_amdhsa_kernel
.p2align 6
.amdhsa_kernel fin_kernel
  .amdhsa_next_free_vgpr 64
  .amdhsa_next_free_sgpr 102
  .amdhsa_accum_offset 64
  .amdhsa_group_segment_fixed_size 0
  .amdhsa_kernarg_size 96
  .amdhsa_user_sgpr_count 2
  .amdhsa_user_sgpr_kernarg_segment_ptr 1
  .amdhsa_system_sgpr_workgroup_id_x 1
.end_amdhsa_kernel
```
